```python
import torch

def _softmax(x, axis=-1):
    return torch.softmax(x, dim=axis)
def _gelu(x):
    return torch.nn.functional.gelu(x, approximate="tanh")
def _silu(x):
    return torch.nn.functional.silu(x)
def _sigmoid(x):
    return torch.sigmoid(x)
def _layernorm(x, axis=-1, eps=1e-5):
    m = x.mean(dim=axis, keepdim=True)
    v = x.var(dim=axis, keepdim=True, unbiased=False)
    return (x - m) / torch.sqrt(v + eps)
def _scatter_add(tgt, idx, src, axis=0):
    return tgt.clone().index_add_(axis, idx, src)
def _segment_sum(src, seg, n):
    out = torch.zeros((n,) + src.shape[1:], dtype=src.dtype)
    return out.index_add_(0, seg, src)
def _pad(x, pw):
    flat = tuple(v for pair in reversed(pw) for v in pair)
    return torch.nn.functional.pad(x, flat)

kernel_name = 'parallel_sum__ssm_conv_h3__dense_activation_silu__prompt'

def setup_inputs():

    _w = (lambda a: (lambda t: t.to(torch.bfloat16) if t.is_floating_point() else t)(torch.as_tensor(a)))
    def _A_setup():
        B, S, D = 1, 2048, 512
        ks = 4
        return {
            "q": _w((lambda *s: torch.randn(*s, dtype=torch.bfloat16) * 0.05)(B, S, D)),
            "k": _w((lambda *s: torch.randn(*s, dtype=torch.bfloat16) * 0.2)(B, S, D)),
            "v": _w((lambda *s: torch.randn(*s, dtype=torch.bfloat16) * 0.2)(B, S, D)),
            "shift_k": _w((lambda *s: torch.randn(*s, dtype=torch.bfloat16) * 0.2)(D, ks) * 0.5),
            "ssm_k": _w((lambda *s: torch.randn(*s, dtype=torch.bfloat16) * 0.8)(D, S) * (1.0 / S ** 0.5)),
            "ssm_D": _w((lambda *s: torch.randn(*s, dtype=torch.bfloat16) * 0.2)(D)),
        }
    _A_in = _A_setup()

    def _B_setup():
        B, S, D, F = 1, 2048, 512, 1792
        return {
            "x": _w((lambda *s: torch.randn(*s, dtype=torch.bfloat16) * 0.05)(B, S, D)),
            "w1": _w((lambda *s: torch.randn(*s, dtype=torch.bfloat16) * 0.8)(D, F) * (D ** -0.5)),
            "w2": _w((lambda *s: torch.randn(*s, dtype=torch.bfloat16) * 0.1)(F, D) * (F ** -0.5)),
        }
    _B_in = _B_setup()

    return {
        "A_q": _A_in["q"],
        "A_k": _A_in["k"],
        "A_v": _A_in["v"],
        "A_shift_k": _A_in["shift_k"],
        "A_ssm_k": _A_in["ssm_k"],
        "A_ssm_D": _A_in["ssm_D"],
        "B_x": _B_in["x"],
        "B_w1": _B_in["w1"],
        "B_w2": _B_in["w2"],
    }

def reference(A_q, A_k, A_v, A_shift_k, A_ssm_k, A_ssm_D, B_x, B_w1, B_w2):
    def _A_ref(q, k, v, shift_k, ssm_k, ssm_D):
        B, S, D = q.shape
        ks = shift_k.shape[-1]
        k_pad = _pad(k, ((0, 0), (ks - 1, 0), (0, 0)))
        k_shift = torch.zeros_like(k)
        for t in range(ks):
            k_shift = k_shift + k_pad[:, t:t + S, :] * shift_k[:, ks - 1 - t][None, None, :]
        kv = k_shift * v
        L = 2 * S
        kv_pad = _pad(kv, ((0, 0), (0, S), (0, 0)))
        kf_pad = _pad(ssm_k, ((0, 0), (0, S)))
        kv_f = (lambda x, axes=(-2,-1): torch.fft.rfft2(x.float(), dim=axes))(kv_pad[:, None, :, :], axes=(1, 2))
        kf_f = (lambda x, axes=(-2,-1): torch.fft.rfft2(x.float(), dim=axes))(kf_pad[:, None, :], axes=(1, 2))
        kf_f = (lambda x, *d: x.permute(*d))(kf_f, 1, 2, 0)
        y_f = kv_f * kf_f[None, :, :, :]
        y = (lambda x, s, axes=(-2,-1): torch.fft.irfft2(x, s=s, dim=axes).to(torch.bfloat16))(y_f, (1, L), axes=(1, 2))[:, 0, :S, :]
        y = y + kv * ssm_D[None, None, :]
        return q * y

    def _B_ref(x, w1, w2):
        h = torch.einsum("bsd,df->bsf", x, w1)
        h = _silu(h)
        out = torch.einsum("bsf,fd->bsd", h, w2)
        return out

    x = A_q
    xn = _layernorm(x, axis=-1)
    return x + _A_ref(xn, A_k, A_v, A_shift_k, A_ssm_k, A_ssm_D) + _B_ref(xn, B_w1, B_w2)
```

```asm
; @launch grid=(256,1,1) block=(512,1,1) lds=163840
.amdgcn_target "amdgcn-amd-amdhsa--gfx950"
.text
.globl parallel_sum__ssm_conv_h3__dense_activation_silu__prompt_kernel
.p2align 8
.type parallel_sum__ssm_conv_h3__dense_activation_silu__prompt_kernel,@function
parallel_sum__ssm_conv_h3__dense_activation_silu__prompt_kernel:
    s_cmp_ge_u32 s2, 256
    s_cbranch_scc1 L_end
    s_load_dwordx16 s[4:19], s[0:1], 0
    s_load_dwordx8 s[20:27], s[0:1], 64
    v_lshrrev_b32 v1, 6, v0
    v_and_b32 v2, 63, v0
    v_readfirstlane_b32 s3, v1
    s_getpc_b64 s[64:65]
L_pc0:
    v_lshlrev_b32 v12, 7, v2
    s_cmp_eq_u32 s3, 7
    s_cbranch_scc0 L_nopre0_1
    s_lshr_b32 s66, s2, 3
    s_cmp_lt_u32 s66, 4
    s_cbranch_scc0 L_nopre0_1
    s_lshl_b32 s66, s66, 13
    v_add_u32 v13, s66, v12
    v_min_u32 v13, L_code_end-L_pc0-4, v13
    global_load_dword v178, v13, s[64:65]
L_nopre0_1:
    s_and_b32 s33, s2, 7
    s_lshr_b32 s34, s2, 3
    s_and_b32 s60, s34, 3
    s_lshr_b32 s61, s34, 2
    s_and_b32 s35, s33, 3
    s_lshl_b32 s35, s35, 2
    s_add_u32 s35, s35, s60
    s_lshr_b32 s36, s33, 2
    s_lshl_b32 s36, s36, 3
    s_add_u32 s36, s36, s61
    s_lshl_b32 s37, s33, 2
    s_add_u32 s37, s37, s60
    s_mov_b32 s38, s61
    v_and_b32 v3, 15, v2
    v_lshrrev_b32 v4, 4, v2
    v_mov_b32 v5, 0
    s_mov_b32 s62, 32768
    s_waitcnt lgkmcnt(0)
    s_mov_b32 s17, 0
    s_mov_b32 s16, 0
    s_mov_b32 s28, s26
    s_mov_b32 s29, s27
    s_mov_b32 s30, 1048576
    s_mov_b32 s31, 0x00020000
    s_load_dword s32, s[26:27], 0x8000
    s_cmp_ge_u32 s3, 4
    s_cbranch_scc1 L_loader
    s_mov_b32 s40, s6
    s_mov_b32 s41, s7
    s_mov_b32 s42, 2097152
    s_mov_b32 s43, 0x00020000
    s_mov_b32 s44, s8
    s_mov_b32 s45, s9
    s_mov_b32 s46, 2097152
    s_mov_b32 s47, 0x00020000
    s_mov_b32 s48, s10
    s_mov_b32 s49, s11
    s_mov_b32 s50, 4096
    s_mov_b32 s51, 0x00020000
    v_and_b32 v8, 7, v0
    v_lshrrev_b32 v9, 3, v0
    s_lshl_b32 s60, s34, 16
    s_lshl_b32 s61, s33, 7
    s_add_u32 s60, s60, s61
    v_lshrrev_b32 v10, 3, v2
    v_lshlrev_b32 v10, 10, v10
    v_and_b32 v11, 7, v2
    v_lshl_add_u32 v10, v11, 4, v10
    s_lshl_b32 s61, s3, 14
    s_add_u32 s61, s61, s60
    v_add_u32 v10, s61, v10
    v_add_u32 v11, 0xffffe000, v10
    v_add_u32 v12, 0x2000, v10
    s_lshl_b32 s62, s3, 12
    v_lshlrev_b32 v13, 11, v9
    v_lshl_add_u32 v13, v8, 4, v13
    v_add_u32 v13, s60, v13
    v_lshlrev_b32 v14, 4, v2
    s_add_u32 m0, s62, 133120
    s_mov_b32 s63, 0
    buffer_load_dwordx4 v11, s[40:43], s63 offen lds
    s_add_u32 m0, m0, 1024
    s_lshl_b32 s61, s33, 9
    buffer_load_dwordx4 v10, s[40:43], s63 offen lds
    s_add_u32 m0, m0, 1024
    s_add_u32 s61, s61, 0
    buffer_load_dwordx4 v12, s[40:43], s63 offen lds
    buffer_load_dwordx4 v[36:39], v13, s[44:47], s63 offen
    buffer_load_dwordx4 v[40:43], v13, s[44:47], s63 offen offset:1024
    s_add_u32 m0, m0, 1024
    s_mov_b32 exec_hi, 0
    buffer_load_dwordx4 v14, s[48:51], s61 offen lds
    s_mov_b32 exec_hi, -1
    v_lshrrev_b32 v15, 3, v2
    v_lshlrev_b32 v15, 8, v15
    v_lshl_add_u32 v15, v8, 4, v15
    s_add_u32 s62, s62, 133120
    v_add_u32 v15, s62, v15
    v_lshlrev_b32 v1, 6, v8
    v_add_u32 v1, s62, v1
    v_mov_b32 v206, v15
    v_mov_b32 v207, v1
    s_barrier
    s_add_u32 s52, s26, 1048576
    s_addc_u32 s53, s27, 0
    s_mov_b32 s54, 2097152
    s_mov_b32 s55, 0x00020000
    s_add_u32 s56, s26, 5242880
    s_addc_u32 s57, s27, 0
    s_mov_b32 s58, 7340032
    s_mov_b32 s59, 0x00020000
    v_and_b32 v5, 7, v3
    v_xor_b32 v5, v5, v4
    v_lshlrev_b32 v5, 4, v5
    s_lshl_b32 s60, s3, 5
    v_add_u32 v6, s60, v3
    v_lshl_add_u32 v168, v6, 7, v5
    v_add_u32 v168, 40960, v168
    v_xor_b32 v169, 64, v168
    v_lshrrev_b32 v5, 1, v4
    v_lshlrev_b32 v5, 4, v5
    v_and_b32 v6, 1, v4
    v_lshl_add_u32 v5, v6, 2, v5
    v_lshrrev_b32 v6, 2, v3
    v_add_u32 v5, v5, v6
    v_mul_u32_u24 v5, 224, v5
    v_and_b32 v6, 3, v3
    v_lshl_add_u32 v5, v6, 3, v5
    v_add_u32 v5, 57344, v5
    s_lshl_b32 s64, s3, 1
    s_add_u32 s64, s64, 0
    s_cmp_ge_u32 s64, 7
    s_cselect_b32 s60, 7, 0
    s_sub_u32 s64, s64, s60
    s_lshl_b32 s60, s64, 5
    v_add_u32 v170, s60, v5
    s_lshl_b32 s65, s3, 1
    s_add_u32 s65, s65, 1
    s_cmp_ge_u32 s65, 7
    s_cselect_b32 s60, 7, 0
    s_sub_u32 s65, s65, s60
    s_lshl_b32 s60, s65, 5
    v_add_u32 v171, s60, v5
    s_lshl_b32 s66, s3, 1
    s_add_u32 s66, s66, 2
    s_cmp_ge_u32 s66, 7
    s_cselect_b32 s60, 7, 0
    s_sub_u32 s66, s66, s60
    s_lshl_b32 s60, s66, 5
    v_add_u32 v172, s60, v5
    s_lshl_b32 s67, s3, 1
    s_add_u32 s67, s67, 3
    s_cmp_ge_u32 s67, 7
    s_cselect_b32 s60, 7, 0
    s_sub_u32 s67, s67, s60
    s_lshl_b32 s60, s67, 5
    v_add_u32 v173, s60, v5
    s_lshl_b32 s68, s3, 1
    s_add_u32 s68, s68, 4
    s_cmp_ge_u32 s68, 7
    s_cselect_b32 s60, 7, 0
    s_sub_u32 s68, s68, s60
    s_lshl_b32 s60, s68, 5
    v_add_u32 v174, s60, v5
    s_lshl_b32 s69, s3, 1
    s_add_u32 s69, s69, 5
    s_cmp_ge_u32 s69, 7
    s_cselect_b32 s60, 7, 0
    s_sub_u32 s69, s69, s60
    s_lshl_b32 s60, s69, 5
    v_add_u32 v175, s60, v5
    s_lshl_b32 s70, s3, 1
    s_add_u32 s70, s70, 6
    s_cmp_ge_u32 s70, 7
    s_cselect_b32 s60, 7, 0
    s_sub_u32 s70, s70, s60
    s_lshl_b32 s60, s70, 5
    v_add_u32 v176, s60, v5
    s_lshr_b32 s71, s3, 1
    s_and_b32 s72, s3, 1
    v_lshrrev_b32 v5, 2, v3
    v_lshlrev_b32 v5, 2, v5
    v_lshl_add_u32 v5, v4, 3, v5
    v_and_b32 v6, 3, v3
    v_sub_u32 v6, 3, v6
    v_lshlrev_b32 v6, 6, v6
    s_lshl_b32 s60, s71, 14
    s_add_u32 s60, s60, 8192
    v_add_u32 v7, -12, v5
    v_cmp_gt_i32 vcc, 0, v7
    v_lshl_add_u32 v182, v7, 1, v6
    v_add_u32 v182, s60, v182
    s_nop 0
    v_cndmask_b32 v15, 0, -1, vcc
    v_and_b32 v1, 192, v15
    v_sub_u32 v182, v182, v1
    v_not_b32 v185, v15
    v_add_u32 v7, -8, v5
    v_cmp_gt_i32 vcc, 0, v7
    v_lshl_add_u32 v183, v7, 1, v6
    v_add_u32 v183, s60, v183
    s_nop 0
    v_cndmask_b32 v15, 0, -1, vcc
    v_and_b32 v1, 192, v15
    v_sub_u32 v183, v183, v1
    v_not_b32 v186, v15
    s_cmp_eq_u32 s72, 0
    s_cbranch_scc1 L_cm0_2
    v_mov_b32 v185, -1
    v_mov_b32 v186, -1
    v_add_u32 v182, 1024, v182
    v_add_u32 v183, 1024, v183
L_cm0_2:
    v_lshlrev_b32 v5, 4, v4
    v_lshlrev_b32 v6, 5, v3
    v_sub_u32 v187, v5, v6
    s_lshl_b32 s60, s72, 8
    v_add_u32 v187, s60, v187
    s_lshl_b32 s60, s71, 12
    s_add_u32 s60, s60, 480
    v_add_u32 v184, s60, v187
    s_waitcnt lgkmcnt(0)
    s_mul_i32 s32, s32, 0x9E3779B1
    s_add_u32 s32, s32, 0x7F4A7C15
    v_mov_b32 v104, 0
    v_mov_b32 v105, 0
    v_mov_b32 v106, 0
    v_mov_b32 v107, 0
    v_mov_b32 v108, 0
    v_mov_b32 v109, 0
    v_mov_b32 v110, 0
    v_mov_b32 v111, 0
    v_mov_b32 v112, 0
    v_mov_b32 v113, 0
    v_mov_b32 v114, 0
    v_mov_b32 v115, 0
    v_mov_b32 v116, 0
    v_mov_b32 v117, 0
    v_mov_b32 v118, 0
    v_mov_b32 v119, 0
    v_mov_b32 v120, 0
    v_mov_b32 v121, 0
    v_mov_b32 v122, 0
    v_mov_b32 v123, 0
    v_mov_b32 v124, 0
    v_mov_b32 v125, 0
    v_mov_b32 v126, 0
    v_mov_b32 v127, 0
    v_mov_b32 v128, 0
    v_mov_b32 v129, 0
    v_mov_b32 v130, 0
    v_mov_b32 v131, 0
    v_mov_b32 v132, 0
    v_mov_b32 v133, 0
    v_mov_b32 v134, 0
    v_mov_b32 v135, 0
    v_mov_b32 v136, 0
    v_mov_b32 v137, 0
    v_mov_b32 v138, 0
    v_mov_b32 v139, 0
    v_mov_b32 v140, 0
    v_mov_b32 v141, 0
    v_mov_b32 v142, 0
    v_mov_b32 v143, 0
    v_mov_b32 v144, 0
    v_mov_b32 v145, 0
    v_mov_b32 v146, 0
    v_mov_b32 v147, 0
    v_mov_b32 v148, 0
    v_mov_b32 v149, 0
    v_mov_b32 v150, 0
    v_mov_b32 v151, 0
    v_mov_b32 v152, 0
    v_mov_b32 v153, 0
    v_mov_b32 v154, 0
    v_mov_b32 v155, 0
    v_mov_b32 v156, 0
    v_mov_b32 v157, 0
    v_mov_b32 v158, 0
    v_mov_b32 v159, 0
    v_mov_b32 v160, 0
    v_mov_b32 v161, 0
    v_mov_b32 v162, 0
    v_mov_b32 v163, 0
    v_mov_b32 v164, 0
    v_mov_b32 v165, 0
    v_mov_b32 v166, 0
    v_mov_b32 v167, 0
    s_waitcnt vmcnt(0)
    ds_read_b128 v[16:19], v206 offset:640
    ds_read_b128 v[20:23], v206 offset:768
    ds_read_b128 v[24:27], v206 offset:896
    ds_read_b128 v[28:31], v206 offset:1024
    ds_read_b128 v[32:35], v206 offset:1152
    ds_read_b128 v[44:47], v207 offset:3072
    ds_read_b128 v[48:51], v207 offset:3088
    ds_read_b128 v[52:55], v207 offset:3104
    ds_read_b128 v[56:59], v207 offset:3120
    s_waitcnt lgkmcnt(0)
    v_lshlrev_b32 v64, 16, v16
    v_and_b32 v65, 0xffff0000, v16
    v_lshlrev_b32 v66, 16, v20
    v_and_b32 v67, 0xffff0000, v20
    v_lshlrev_b32 v68, 16, v24
    v_and_b32 v69, 0xffff0000, v24
    v_lshlrev_b32 v70, 16, v28
    v_and_b32 v71, 0xffff0000, v28
    v_lshlrev_b32 v72, 16, v32
    v_and_b32 v73, 0xffff0000, v32
    v_lshlrev_b32 v74, 16, v44
    v_lshlrev_b32 v75, 16, v46
    v_and_b32 v76, 0xffff0000, v44
    v_and_b32 v77, 0xffff0000, v46
    v_lshlrev_b32 v78, 16, v45
    v_lshlrev_b32 v79, 16, v47
    v_and_b32 v80, 0xffff0000, v45
    v_and_b32 v81, 0xffff0000, v47
    v_lshlrev_b32 v82, 16, v36
    v_and_b32 v83, 0xffff0000, v36
    v_lshlrev_b32 v84, 16, v40
    v_and_b32 v85, 0xffff0000, v40
    v_pk_mul_f32 v[86:87], v[70:71], v[74:75]
    v_pk_mul_f32 v[88:89], v[72:73], v[74:75]
    v_pk_fma_f32 v[86:87], v[68:69], v[76:77], v[86:87]
    v_pk_fma_f32 v[88:89], v[70:71], v[76:77], v[88:89]
    v_pk_fma_f32 v[86:87], v[66:67], v[78:79], v[86:87]
    v_pk_fma_f32 v[88:89], v[68:69], v[78:79], v[88:89]
    v_pk_fma_f32 v[86:87], v[64:65], v[80:81], v[86:87]
    v_pk_fma_f32 v[88:89], v[66:67], v[80:81], v[88:89]
    v_pk_mul_f32 v[86:87], v[86:87], v[82:83]
    v_pk_mul_f32 v[88:89], v[88:89], v[84:85]
    v_cvt_pk_bf16_f32 v96, v88, v86
    v_cvt_pk_bf16_f32 v97, v89, v87
    v_lshlrev_b32 v64, 16, v17
    v_and_b32 v65, 0xffff0000, v17
    v_lshlrev_b32 v66, 16, v21
    v_and_b32 v67, 0xffff0000, v21
    v_lshlrev_b32 v68, 16, v25
    v_and_b32 v69, 0xffff0000, v25
    v_lshlrev_b32 v70, 16, v29
    v_and_b32 v71, 0xffff0000, v29
    v_lshlrev_b32 v72, 16, v33
    v_and_b32 v73, 0xffff0000, v33
    v_lshlrev_b32 v74, 16, v48
    v_lshlrev_b32 v75, 16, v50
    v_and_b32 v76, 0xffff0000, v48
    v_and_b32 v77, 0xffff0000, v50
    v_lshlrev_b32 v78, 16, v49
    v_lshlrev_b32 v79, 16, v51
    v_and_b32 v80, 0xffff0000, v49
    v_and_b32 v81, 0xffff0000, v51
    v_lshlrev_b32 v82, 16, v37
    v_and_b32 v83, 0xffff0000, v37
    v_lshlrev_b32 v84, 16, v41
    v_and_b32 v85, 0xffff0000, v41
    v_pk_mul_f32 v[86:87], v[70:71], v[74:75]
    v_pk_mul_f32 v[88:89], v[72:73], v[74:75]
    v_pk_fma_f32 v[86:87], v[68:69], v[76:77], v[86:87]
    v_pk_fma_f32 v[88:89], v[70:71], v[76:77], v[88:89]
    v_pk_fma_f32 v[86:87], v[66:67], v[78:79], v[86:87]
    v_pk_fma_f32 v[88:89], v[68:69], v[78:79], v[88:89]
    v_pk_fma_f32 v[86:87], v[64:65], v[80:81], v[86:87]
    v_pk_fma_f32 v[88:89], v[66:67], v[80:81], v[88:89]
    v_pk_mul_f32 v[86:87], v[86:87], v[82:83]
    v_pk_mul_f32 v[88:89], v[88:89], v[84:85]
    v_cvt_pk_bf16_f32 v98, v88, v86
    v_cvt_pk_bf16_f32 v99, v89, v87
    v_lshlrev_b32 v64, 16, v18
    v_and_b32 v65, 0xffff0000, v18
    v_lshlrev_b32 v66, 16, v22
    v_and_b32 v67, 0xffff0000, v22
    v_lshlrev_b32 v68, 16, v26
    v_and_b32 v69, 0xffff0000, v26
    v_lshlrev_b32 v70, 16, v30
    v_and_b32 v71, 0xffff0000, v30
    v_lshlrev_b32 v72, 16, v34
    v_and_b32 v73, 0xffff0000, v34
    v_lshlrev_b32 v74, 16, v52
    v_lshlrev_b32 v75, 16, v54
    v_and_b32 v76, 0xffff0000, v52
    v_and_b32 v77, 0xffff0000, v54
    v_lshlrev_b32 v78, 16, v53
    v_lshlrev_b32 v79, 16, v55
    v_and_b32 v80, 0xffff0000, v53
    v_and_b32 v81, 0xffff0000, v55
    v_lshlrev_b32 v82, 16, v38
    v_and_b32 v83, 0xffff0000, v38
    v_lshlrev_b32 v84, 16, v42
    v_and_b32 v85, 0xffff0000, v42
    v_pk_mul_f32 v[86:87], v[70:71], v[74:75]
    v_pk_mul_f32 v[88:89], v[72:73], v[74:75]
    v_pk_fma_f32 v[86:87], v[68:69], v[76:77], v[86:87]
    v_pk_fma_f32 v[88:89], v[70:71], v[76:77], v[88:89]
    v_pk_fma_f32 v[86:87], v[66:67], v[78:79], v[86:87]
    v_pk_fma_f32 v[88:89], v[68:69], v[78:79], v[88:89]
    v_pk_fma_f32 v[86:87], v[64:65], v[80:81], v[86:87]
    v_pk_fma_f32 v[88:89], v[66:67], v[80:81], v[88:89]
    v_pk_mul_f32 v[86:87], v[86:87], v[82:83]
    v_pk_mul_f32 v[88:89], v[88:89], v[84:85]
    v_cvt_pk_bf16_f32 v100, v88, v86
    v_cvt_pk_bf16_f32 v101, v89, v87
    v_lshlrev_b32 v64, 16, v19
    v_and_b32 v65, 0xffff0000, v19
    v_lshlrev_b32 v66, 16, v23
    v_and_b32 v67, 0xffff0000, v23
    v_lshlrev_b32 v68, 16, v27
    v_and_b32 v69, 0xffff0000, v27
    v_lshlrev_b32 v70, 16, v31
    v_and_b32 v71, 0xffff0000, v31
    v_lshlrev_b32 v72, 16, v35
    v_and_b32 v73, 0xffff0000, v35
    v_lshlrev_b32 v74, 16, v56
    v_lshlrev_b32 v75, 16, v58
    v_and_b32 v76, 0xffff0000, v56
    v_and_b32 v77, 0xffff0000, v58
    v_lshlrev_b32 v78, 16, v57
    v_lshlrev_b32 v79, 16, v59
    v_and_b32 v80, 0xffff0000, v57
    v_and_b32 v81, 0xffff0000, v59
    v_lshlrev_b32 v82, 16, v39
    v_and_b32 v83, 0xffff0000, v39
    v_lshlrev_b32 v84, 16, v43
    v_and_b32 v85, 0xffff0000, v43
    v_pk_mul_f32 v[86:87], v[70:71], v[74:75]
    v_pk_mul_f32 v[88:89], v[72:73], v[74:75]
    v_pk_fma_f32 v[86:87], v[68:69], v[76:77], v[86:87]
    v_pk_fma_f32 v[88:89], v[70:71], v[76:77], v[88:89]
    v_pk_fma_f32 v[86:87], v[66:67], v[78:79], v[86:87]
    v_pk_fma_f32 v[88:89], v[68:69], v[78:79], v[88:89]
    v_pk_fma_f32 v[86:87], v[64:65], v[80:81], v[86:87]
    v_pk_fma_f32 v[88:89], v[66:67], v[80:81], v[88:89]
    v_pk_mul_f32 v[86:87], v[86:87], v[82:83]
    v_pk_mul_f32 v[88:89], v[88:89], v[84:85]
    v_cvt_pk_bf16_f32 v102, v88, v86
    v_cvt_pk_bf16_f32 v103, v89, v87
    v_sub_u32 v10, 31, v9
    v_lshlrev_b32 v11, 2, v8
    v_xor_b32 v10, v10, v11
    v_lshlrev_b32 v10, 2, v10
    v_lshl_add_u32 v10, v8, 10, v10
    ds_write_b32 v10, v96 offset:0
    ds_write_b32 v10, v97 offset:128
    ds_write_b32 v10, v98 offset:256
    ds_write_b32 v10, v99 offset:384
    ds_write_b32 v10, v100 offset:512
    ds_write_b32 v10, v101 offset:640
    ds_write_b32 v10, v102 offset:768
    ds_write_b32 v10, v103 offset:896
    v_lshrrev_b32 v11, 3, v9
    v_xor_b32 v11, v11, v8
    v_lshlrev_b32 v11, 4, v11
    v_lshl_add_u32 v11, v9, 7, v11
    v_xor_b32 v12, 64, v11
    v_lshlrev_b32 v13, 12, v9
    v_lshl_add_u32 v13, v8, 4, v13
    s_lshl_b32 s60, s33, 18
    s_lshl_b32 s61, s34, 7
    s_sub_u32 s61, 3968, s61
    s_add_u32 s60, s60, s61
    s_add_u32 s61, s60, 131072
    s_waitcnt lgkmcnt(0)
    s_barrier
    ds_read_b128 v[16:19], v11
    ds_read_b128 v[20:23], v12 offset:4096
    ds_read_b128 v[60:63], v168 offset:0
    ds_read_b128 v[64:67], v168 offset:2048
    ds_read_b64_tr_b16 v[32:33], v170 offset:0
    ds_read_b64_tr_b16 v[34:35], v170 offset:1792
    ds_read_b64_tr_b16 v[36:37], v171 offset:0
    ds_read_b64_tr_b16 v[38:39], v171 offset:1792
    ds_read_b64_tr_b16 v[40:41], v172 offset:0
    ds_read_b64_tr_b16 v[42:43], v172 offset:1792
    ds_read_b64_tr_b16 v[44:45], v173 offset:0
    ds_read_b64_tr_b16 v[46:47], v173 offset:1792
    ds_read_b64_tr_b16 v[48:49], v174 offset:0
    ds_read_b64_tr_b16 v[50:51], v174 offset:1792
    ds_read_b64_tr_b16 v[52:53], v175 offset:0
    ds_read_b64_tr_b16 v[54:55], v175 offset:1792
    ds_read_b64_tr_b16 v[56:57], v176 offset:0
    ds_read_b64_tr_b16 v[58:59], v176 offset:1792
    v_mov_b32 v24, 0x3f803f80
    v_mov_b32 v25, 0x3f803f80
    v_mov_b32 v26, 0x3f803f80
    v_mov_b32 v27, 0x3f803f80
    s_waitcnt lgkmcnt(0)
    buffer_store_dwordx4 v[16:19], v13, s[52:55], s60 offen sc1
    buffer_store_dwordx4 v[20:23], v13, s[52:55], s61 offen sc1
    s_mov_b32 s60, 0
    s_mov_b32 s62, 4294875136
    s_mov_b32 s63, 30720
L_g1loop:
    s_and_b32 s61, s60, 3
    s_cmp_eq_u32 s61, 3
    s_cselect_b32 s61, s62, s63
    v_mfma_f32_16x16x32_bf16 v[104:107], v[32:35], v[60:63], v[104:107]
    ds_read_b128 v[96:99], v169 offset:0
    ds_read_b128 v[100:103], v169 offset:2048
    v_mfma_f32_16x16x32_bf16 v[108:111], v[32:35], v[64:67], v[108:111]
    ds_read_b64_tr_b16 v[68:69], v170 offset:7168
    ds_read_b64_tr_b16 v[70:71], v170 offset:8960
    v_mfma_f32_16x16x32_bf16 v[160:163], v[32:35], v[24:27], v[160:163]
    ds_read_b64_tr_b16 v[72:73], v171 offset:7168
    ds_read_b64_tr_b16 v[74:75], v171 offset:8960
    v_mfma_f32_16x16x32_bf16 v[112:115], v[36:39], v[60:63], v[112:115]
    ds_read_b64_tr_b16 v[76:77], v172 offset:7168
    ds_read_b64_tr_b16 v[78:79], v172 offset:8960
    v_mfma_f32_16x16x32_bf16 v[116:119], v[36:39], v[64:67], v[116:119]
    ds_read_b64_tr_b16 v[80:81], v173 offset:7168
    ds_read_b64_tr_b16 v[82:83], v173 offset:8960
    v_mfma_f32_16x16x32_bf16 v[164:167], v[36:39], v[24:27], v[164:167]
    ds_read_b64_tr_b16 v[84:85], v174 offset:7168
    ds_read_b64_tr_b16 v[86:87], v174 offset:8960
    v_mfma_f32_16x16x32_bf16 v[120:123], v[40:43], v[60:63], v[120:123]
    ds_read_b64_tr_b16 v[88:89], v175 offset:7168
    ds_read_b64_tr_b16 v[90:91], v175 offset:8960
    v_mfma_f32_16x16x32_bf16 v[124:127], v[40:43], v[64:67], v[124:127]
    ds_read_b64_tr_b16 v[92:93], v176 offset:7168
    ds_read_b64_tr_b16 v[94:95], v176 offset:8960
    v_mfma_f32_16x16x32_bf16 v[128:131], v[44:47], v[60:63], v[128:131]
    v_mfma_f32_16x16x32_bf16 v[132:135], v[44:47], v[64:67], v[132:135]
    v_add_u32 v168, s61, v168
    v_add_u32 v169, s61, v169
    v_mfma_f32_16x16x32_bf16 v[136:139], v[48:51], v[60:63], v[136:139]
    v_add_u32 v170, s61, v170
    v_add_u32 v171, s61, v171
    v_mfma_f32_16x16x32_bf16 v[140:143], v[48:51], v[64:67], v[140:143]
    v_add_u32 v172, s61, v172
    v_add_u32 v173, s61, v173
    v_mfma_f32_16x16x32_bf16 v[144:147], v[52:55], v[60:63], v[144:147]
    v_add_u32 v174, s61, v174
    v_add_u32 v175, s61, v175
    v_mfma_f32_16x16x32_bf16 v[148:151], v[52:55], v[64:67], v[148:151]
    v_add_u32 v176, s61, v176
    v_mfma_f32_16x16x32_bf16 v[152:155], v[56:59], v[60:63], v[152:155]
    v_mfma_f32_16x16x32_bf16 v[156:159], v[56:59], v[64:67], v[156:159]
    s_cmp_eq_u32 s60, 1
    s_cbranch_scc0 L_nodrain_3
    s_waitcnt vmcnt(0)
L_nodrain_3:
    s_waitcnt lgkmcnt(0)
    s_barrier
    v_mfma_f32_16x16x32_bf16 v[104:107], v[68:71], v[96:99], v[104:107]
    ds_read_b128 v[60:63], v168 offset:0
    ds_read_b128 v[64:67], v168 offset:2048
    v_mfma_f32_16x16x32_bf16 v[108:111], v[68:71], v[100:103], v[108:111]
    ds_read_b64_tr_b16 v[32:33], v170 offset:0
    ds_read_b64_tr_b16 v[34:35], v170 offset:1792
    v_mfma_f32_16x16x32_bf16 v[160:163], v[68:71], v[24:27], v[160:163]
    ds_read_b64_tr_b16 v[36:37], v171 offset:0
    ds_read_b64_tr_b16 v[38:39], v171 offset:1792
    v_mfma_f32_16x16x32_bf16 v[112:115], v[72:75], v[96:99], v[112:115]
    ds_read_b64_tr_b16 v[40:41], v172 offset:0
    ds_read_b64_tr_b16 v[42:43], v172 offset:1792
    v_mfma_f32_16x16x32_bf16 v[116:119], v[72:75], v[100:103], v[116:119]
    ds_read_b64_tr_b16 v[44:45], v173 offset:0
    ds_read_b64_tr_b16 v[46:47], v173 offset:1792
    v_mfma_f32_16x16x32_bf16 v[164:167], v[72:75], v[24:27], v[164:167]
    ds_read_b64_tr_b16 v[48:49], v174 offset:0
    ds_read_b64_tr_b16 v[50:51], v174 offset:1792
    v_mfma_f32_16x16x32_bf16 v[120:123], v[76:79], v[96:99], v[120:123]
    ds_read_b64_tr_b16 v[52:53], v175 offset:0
    ds_read_b64_tr_b16 v[54:55], v175 offset:1792
    v_mfma_f32_16x16x32_bf16 v[124:127], v[76:79], v[100:103], v[124:127]
    ds_read_b64_tr_b16 v[56:57], v176 offset:0
    ds_read_b64_tr_b16 v[58:59], v176 offset:1792
    v_mfma_f32_16x16x32_bf16 v[128:131], v[80:83], v[96:99], v[128:131]
    v_mfma_f32_16x16x32_bf16 v[132:135], v[80:83], v[100:103], v[132:135]
    v_mfma_f32_16x16x32_bf16 v[136:139], v[84:87], v[96:99], v[136:139]
    v_mfma_f32_16x16x32_bf16 v[140:143], v[84:87], v[100:103], v[140:143]
    v_mfma_f32_16x16x32_bf16 v[144:147], v[88:91], v[96:99], v[144:147]
    v_mfma_f32_16x16x32_bf16 v[148:151], v[88:91], v[100:103], v[148:151]
    v_mfma_f32_16x16x32_bf16 v[152:155], v[92:95], v[96:99], v[152:155]
    v_mfma_f32_16x16x32_bf16 v[156:159], v[92:95], v[100:103], v[156:159]
    s_add_u32 s60, s60, 1
    s_cmp_lt_u32 s60, 8
    s_waitcnt lgkmcnt(0)
    s_cbranch_scc1 L_g1loop
    s_nop 7
    v_lshlrev_b32 v5, 4, v4
    s_mov_b32 exec_lo, 0x00010001
    s_mov_b32 exec_hi, 0x00010001
    s_lshl_b32 s60, s64, 6
    v_add_u32 v6, s60, v5
    ds_write_b128 v6, v[160:163] offset:40960
    s_lshl_b32 s60, s65, 6
    v_add_u32 v6, s60, v5
    ds_write_b128 v6, v[164:167] offset:40960
    s_mov_b64 exec, -1
    s_waitcnt lgkmcnt(0)
    s_barrier
    s_lshl_b32 s60, s64, 6
    v_add_u32 v6, s60, v5
    ds_read_b128 v[32:35], v6 offset:40960
    s_lshl_b32 s60, s65, 6
    v_add_u32 v6, s60, v5
    ds_read_b128 v[36:39], v6 offset:40960
    s_lshl_b32 s60, s66, 6
    v_add_u32 v6, s60, v5
    ds_read_b128 v[40:43], v6 offset:40960
    s_lshl_b32 s60, s67, 6
    v_add_u32 v6, s60, v5
    ds_read_b128 v[44:47], v6 offset:40960
    s_lshl_b32 s60, s68, 6
    v_add_u32 v6, s60, v5
    ds_read_b128 v[48:51], v6 offset:40960
    s_lshl_b32 s60, s69, 6
    v_add_u32 v6, s60, v5
    ds_read_b128 v[52:55], v6 offset:40960
    s_lshl_b32 s60, s70, 6
    v_add_u32 v6, s60, v5
    ds_read_b128 v[56:59], v6 offset:40960
    s_lshl_b32 s60, s3, 5
    v_add_u32 v6, s60, v3
    v_lshlrev_b32 v6, 3, v6
    ds_read_b64 v[8:9], v6 offset:41472
    ds_read_b64 v[10:11], v6 offset:41600
    v_and_b32 v5, 1, v4
    v_mul_u32_u24 v5, 57344, v5
    v_lshrrev_b32 v6, 1, v4
    v_lshl_add_u32 v5, v6, 8, v5
    v_lshl_add_u32 v5, v3, 4, v5
    s_lshl_b32 s60, s35, 3
    s_lshl_b32 s61, s3, 1
    s_add_u32 s60, s60, s61
    s_mul_i32 s60, s60, 57344
    s_mul_i32 s61, s36, 3584
    s_add_u32 s60, s60, s61
    s_waitcnt lgkmcnt(0)
    v_rcp_f32 v60, v9
    v_rcp_f32 v62, v11
    s_nop 0
    v_mul_f32 v60, 0xbfb8aa3b, v60
    v_mul_f32 v62, 0xbfb8aa3b, v62
    v_pk_fma_f32 v[64:65], v[32:33], v[8:9], v[104:105] op_sel_hi:[1,0,1] neg_lo:[0,1,0] neg_hi:[0,1,0]
    v_pk_fma_f32 v[66:67], v[34:35], v[8:9], v[106:107] op_sel_hi:[1,0,1] neg_lo:[0,1,0] neg_hi:[0,1,0]
    v_pk_fma_f32 v[68:69], v[32:33], v[10:11], v[108:109] op_sel_hi:[1,0,1] neg_lo:[0,1,0] neg_hi:[0,1,0]
    v_pk_fma_f32 v[70:71], v[34:35], v[10:11], v[110:111] op_sel_hi:[1,0,1] neg_lo:[0,1,0] neg_hi:[0,1,0]
    v_pk_mul_f32 v[72:73], v[64:65], v[60:61] op_sel_hi:[1,0]
    v_pk_mul_f32 v[74:75], v[66:67], v[60:61] op_sel_hi:[1,0]
    v_pk_mul_f32 v[76:77], v[68:69], v[62:63] op_sel_hi:[1,0]
    v_pk_mul_f32 v[78:79], v[70:71], v[62:63] op_sel_hi:[1,0]
    v_exp_f32 v72, v72
    v_exp_f32 v73, v73
    v_exp_f32 v74, v74
    v_exp_f32 v75, v75
    v_exp_f32 v76, v76
    v_exp_f32 v77, v77
    v_exp_f32 v78, v78
    v_exp_f32 v79, v79
    v_pk_fma_f32 v[72:73], v[72:73], v[8:9], v[8:9] op_sel:[0,1,1] op_sel_hi:[1,1,1]
    v_pk_fma_f32 v[74:75], v[74:75], v[8:9], v[8:9] op_sel:[0,1,1] op_sel_hi:[1,1,1]
    v_pk_fma_f32 v[76:77], v[76:77], v[10:11], v[10:11] op_sel:[0,1,1] op_sel_hi:[1,1,1]
    v_pk_fma_f32 v[78:79], v[78:79], v[10:11], v[10:11] op_sel:[0,1,1] op_sel_hi:[1,1,1]
    v_rcp_f32 v72, v72
    v_rcp_f32 v73, v73
    v_rcp_f32 v74, v74
    v_rcp_f32 v75, v75
    v_rcp_f32 v76, v76
    v_rcp_f32 v77, v77
    v_rcp_f32 v78, v78
    v_rcp_f32 v79, v79
    v_pk_mul_f32 v[64:65], v[64:65], v[72:73]
    v_pk_mul_f32 v[66:67], v[66:67], v[74:75]
    v_pk_mul_f32 v[68:69], v[68:69], v[76:77]
    v_pk_mul_f32 v[70:71], v[70:71], v[78:79]
    v_cvt_pk_bf16_f32 v80, v64, v65
    v_cvt_pk_bf16_f32 v81, v66, v67
    v_cvt_pk_bf16_f32 v82, v68, v69
    v_cvt_pk_bf16_f32 v83, v70, v71
    s_lshl_b32 s61, s64, 9
    s_add_u32 s61, s61, s60
    v_permlane16_swap_b32 v80, v82
    v_permlane16_swap_b32 v81, v83
    buffer_store_dwordx4 v[80:83], v5, s[56:59], s61 offen sc1
    v_pk_fma_f32 v[64:65], v[36:37], v[8:9], v[112:113] op_sel_hi:[1,0,1] neg_lo:[0,1,0] neg_hi:[0,1,0]
    v_pk_fma_f32 v[66:67], v[38:39], v[8:9], v[114:115] op_sel_hi:[1,0,1] neg_lo:[0,1,0] neg_hi:[0,1,0]
    v_pk_fma_f32 v[68:69], v[36:37], v[10:11], v[116:117] op_sel_hi:[1,0,1] neg_lo:[0,1,0] neg_hi:[0,1,0]
    v_pk_fma_f32 v[70:71], v[38:39], v[10:11], v[118:119] op_sel_hi:[1,0,1] neg_lo:[0,1,0] neg_hi:[0,1,0]
    v_pk_mul_f32 v[72:73], v[64:65], v[60:61] op_sel_hi:[1,0]
    v_pk_mul_f32 v[74:75], v[66:67], v[60:61] op_sel_hi:[1,0]
    v_pk_mul_f32 v[76:77], v[68:69], v[62:63] op_sel_hi:[1,0]
    v_pk_mul_f32 v[78:79], v[70:71], v[62:63] op_sel_hi:[1,0]
    v_exp_f32 v72, v72
    v_exp_f32 v73, v73
    v_exp_f32 v74, v74
    v_exp_f32 v75, v75
    v_exp_f32 v76, v76
    v_exp_f32 v77, v77
    v_exp_f32 v78, v78
    v_exp_f32 v79, v79
    v_pk_fma_f32 v[72:73], v[72:73], v[8:9], v[8:9] op_sel:[0,1,1] op_sel_hi:[1,1,1]
    v_pk_fma_f32 v[74:75], v[74:75], v[8:9], v[8:9] op_sel:[0,1,1] op_sel_hi:[1,1,1]
    v_pk_fma_f32 v[76:77], v[76:77], v[10:11], v[10:11] op_sel:[0,1,1] op_sel_hi:[1,1,1]
    v_pk_fma_f32 v[78:79], v[78:79], v[10:11], v[10:11] op_sel:[0,1,1] op_sel_hi:[1,1,1]
    v_rcp_f32 v72, v72
    v_rcp_f32 v73, v73
    v_rcp_f32 v74, v74
    v_rcp_f32 v75, v75
    v_rcp_f32 v76, v76
    v_rcp_f32 v77, v77
    v_rcp_f32 v78, v78
    v_rcp_f32 v79, v79
    v_pk_mul_f32 v[64:65], v[64:65], v[72:73]
    v_pk_mul_f32 v[66:67], v[66:67], v[74:75]
    v_pk_mul_f32 v[68:69], v[68:69], v[76:77]
    v_pk_mul_f32 v[70:71], v[70:71], v[78:79]
    v_cvt_pk_bf16_f32 v84, v64, v65
    v_cvt_pk_bf16_f32 v85, v66, v67
    v_cvt_pk_bf16_f32 v86, v68, v69
    v_cvt_pk_bf16_f32 v87, v70, v71
    s_lshl_b32 s61, s65, 9
    s_add_u32 s61, s61, s60
    v_permlane16_swap_b32 v84, v86
    v_permlane16_swap_b32 v85, v87
    buffer_store_dwordx4 v[84:87], v5, s[56:59], s61 offen sc1
    v_pk_fma_f32 v[64:65], v[40:41], v[8:9], v[120:121] op_sel_hi:[1,0,1] neg_lo:[0,1,0] neg_hi:[0,1,0]
    v_pk_fma_f32 v[66:67], v[42:43], v[8:9], v[122:123] op_sel_hi:[1,0,1] neg_lo:[0,1,0] neg_hi:[0,1,0]
    v_pk_fma_f32 v[68:69], v[40:41], v[10:11], v[124:125] op_sel_hi:[1,0,1] neg_lo:[0,1,0] neg_hi:[0,1,0]
    v_pk_fma_f32 v[70:71], v[42:43], v[10:11], v[126:127] op_sel_hi:[1,0,1] neg_lo:[0,1,0] neg_hi:[0,1,0]
    v_pk_mul_f32 v[72:73], v[64:65], v[60:61] op_sel_hi:[1,0]
    v_pk_mul_f32 v[74:75], v[66:67], v[60:61] op_sel_hi:[1,0]
    v_pk_mul_f32 v[76:77], v[68:69], v[62:63] op_sel_hi:[1,0]
    v_pk_mul_f32 v[78:79], v[70:71], v[62:63] op_sel_hi:[1,0]
    v_exp_f32 v72, v72
    v_exp_f32 v73, v73
    v_exp_f32 v74, v74
    v_exp_f32 v75, v75
    v_exp_f32 v76, v76
    v_exp_f32 v77, v77
    v_exp_f32 v78, v78
    v_exp_f32 v79, v79
    v_pk_fma_f32 v[72:73], v[72:73], v[8:9], v[8:9] op_sel:[0,1,1] op_sel_hi:[1,1,1]
    v_pk_fma_f32 v[74:75], v[74:75], v[8:9], v[8:9] op_sel:[0,1,1] op_sel_hi:[1,1,1]
    v_pk_fma_f32 v[76:77], v[76:77], v[10:11], v[10:11] op_sel:[0,1,1] op_sel_hi:[1,1,1]
    v_pk_fma_f32 v[78:79], v[78:79], v[10:11], v[10:11] op_sel:[0,1,1] op_sel_hi:[1,1,1]
    v_rcp_f32 v72, v72
    v_rcp_f32 v73, v73
    v_rcp_f32 v74, v74
    v_rcp_f32 v75, v75
    v_rcp_f32 v76, v76
    v_rcp_f32 v77, v77
    v_rcp_f32 v78, v78
    v_rcp_f32 v79, v79
    v_pk_mul_f32 v[64:65], v[64:65], v[72:73]
    v_pk_mul_f32 v[66:67], v[66:67], v[74:75]
    v_pk_mul_f32 v[68:69], v[68:69], v[76:77]
    v_pk_mul_f32 v[70:71], v[70:71], v[78:79]
    v_cvt_pk_bf16_f32 v80, v64, v65
    v_cvt_pk_bf16_f32 v81, v66, v67
    v_cvt_pk_bf16_f32 v82, v68, v69
    v_cvt_pk_bf16_f32 v83, v70, v71
    s_lshl_b32 s61, s66, 9
    s_add_u32 s61, s61, s60
    v_permlane16_swap_b32 v80, v82
    v_permlane16_swap_b32 v81, v83
    buffer_store_dwordx4 v[80:83], v5, s[56:59], s61 offen sc1
    v_pk_fma_f32 v[64:65], v[44:45], v[8:9], v[128:129] op_sel_hi:[1,0,1] neg_lo:[0,1,0] neg_hi:[0,1,0]
    v_pk_fma_f32 v[66:67], v[46:47], v[8:9], v[130:131] op_sel_hi:[1,0,1] neg_lo:[0,1,0] neg_hi:[0,1,0]
    v_pk_fma_f32 v[68:69], v[44:45], v[10:11], v[132:133] op_sel_hi:[1,0,1] neg_lo:[0,1,0] neg_hi:[0,1,0]
    v_pk_fma_f32 v[70:71], v[46:47], v[10:11], v[134:135] op_sel_hi:[1,0,1] neg_lo:[0,1,0] neg_hi:[0,1,0]
    v_pk_mul_f32 v[72:73], v[64:65], v[60:61] op_sel_hi:[1,0]
    v_pk_mul_f32 v[74:75], v[66:67], v[60:61] op_sel_hi:[1,0]
    v_pk_mul_f32 v[76:77], v[68:69], v[62:63] op_sel_hi:[1,0]
    v_pk_mul_f32 v[78:79], v[70:71], v[62:63] op_sel_hi:[1,0]
    v_exp_f32 v72, v72
    v_exp_f32 v73, v73
    v_exp_f32 v74, v74
    v_exp_f32 v75, v75
    v_exp_f32 v76, v76
    v_exp_f32 v77, v77
    v_exp_f32 v78, v78
    v_exp_f32 v79, v79
    v_pk_fma_f32 v[72:73], v[72:73], v[8:9], v[8:9] op_sel:[0,1,1] op_sel_hi:[1,1,1]
    v_pk_fma_f32 v[74:75], v[74:75], v[8:9], v[8:9] op_sel:[0,1,1] op_sel_hi:[1,1,1]
    v_pk_fma_f32 v[76:77], v[76:77], v[10:11], v[10:11] op_sel:[0,1,1] op_sel_hi:[1,1,1]
    v_pk_fma_f32 v[78:79], v[78:79], v[10:11], v[10:11] op_sel:[0,1,1] op_sel_hi:[1,1,1]
    v_rcp_f32 v72, v72
    v_rcp_f32 v73, v73
    v_rcp_f32 v74, v74
    v_rcp_f32 v75, v75
    v_rcp_f32 v76, v76
    v_rcp_f32 v77, v77
    v_rcp_f32 v78, v78
    v_rcp_f32 v79, v79
    v_pk_mul_f32 v[64:65], v[64:65], v[72:73]
    v_pk_mul_f32 v[66:67], v[66:67], v[74:75]
    v_pk_mul_f32 v[68:69], v[68:69], v[76:77]
    v_pk_mul_f32 v[70:71], v[70:71], v[78:79]
    v_cvt_pk_bf16_f32 v84, v64, v65
    v_cvt_pk_bf16_f32 v85, v66, v67
    v_cvt_pk_bf16_f32 v86, v68, v69
    v_cvt_pk_bf16_f32 v87, v70, v71
    s_lshl_b32 s61, s67, 9
    s_add_u32 s61, s61, s60
    v_permlane16_swap_b32 v84, v86
    v_permlane16_swap_b32 v85, v87
    buffer_store_dwordx4 v[84:87], v5, s[56:59], s61 offen sc1
    v_pk_fma_f32 v[64:65], v[48:49], v[8:9], v[136:137] op_sel_hi:[1,0,1] neg_lo:[0,1,0] neg_hi:[0,1,0]
    v_pk_fma_f32 v[66:67], v[50:51], v[8:9], v[138:139] op_sel_hi:[1,0,1] neg_lo:[0,1,0] neg_hi:[0,1,0]
    v_pk_fma_f32 v[68:69], v[48:49], v[10:11], v[140:141] op_sel_hi:[1,0,1] neg_lo:[0,1,0] neg_hi:[0,1,0]
    v_pk_fma_f32 v[70:71], v[50:51], v[10:11], v[142:143] op_sel_hi:[1,0,1] neg_lo:[0,1,0] neg_hi:[0,1,0]
    v_pk_mul_f32 v[72:73], v[64:65], v[60:61] op_sel_hi:[1,0]
    v_pk_mul_f32 v[74:75], v[66:67], v[60:61] op_sel_hi:[1,0]
    v_pk_mul_f32 v[76:77], v[68:69], v[62:63] op_sel_hi:[1,0]
    v_pk_mul_f32 v[78:79], v[70:71], v[62:63] op_sel_hi:[1,0]
    v_exp_f32 v72, v72
    v_exp_f32 v73, v73
    v_exp_f32 v74, v74
    v_exp_f32 v75, v75
    v_exp_f32 v76, v76
    v_exp_f32 v77, v77
    v_exp_f32 v78, v78
    v_exp_f32 v79, v79
    v_pk_fma_f32 v[72:73], v[72:73], v[8:9], v[8:9] op_sel:[0,1,1] op_sel_hi:[1,1,1]
    v_pk_fma_f32 v[74:75], v[74:75], v[8:9], v[8:9] op_sel:[0,1,1] op_sel_hi:[1,1,1]
    v_pk_fma_f32 v[76:77], v[76:77], v[10:11], v[10:11] op_sel:[0,1,1] op_sel_hi:[1,1,1]
    v_pk_fma_f32 v[78:79], v[78:79], v[10:11], v[10:11] op_sel:[0,1,1] op_sel_hi:[1,1,1]
    v_rcp_f32 v72, v72
    v_rcp_f32 v73, v73
    v_rcp_f32 v74, v74
    v_rcp_f32 v75, v75
    v_rcp_f32 v76, v76
    v_rcp_f32 v77, v77
    v_rcp_f32 v78, v78
    v_rcp_f32 v79, v79
    v_pk_mul_f32 v[64:65], v[64:65], v[72:73]
    v_pk_mul_f32 v[66:67], v[66:67], v[74:75]
    v_pk_mul_f32 v[68:69], v[68:69], v[76:77]
    v_pk_mul_f32 v[70:71], v[70:71], v[78:79]
    v_cvt_pk_bf16_f32 v80, v64, v65
    v_cvt_pk_bf16_f32 v81, v66, v67
    v_cvt_pk_bf16_f32 v82, v68, v69
    v_cvt_pk_bf16_f32 v83, v70, v71
    s_lshl_b32 s61, s68, 9
    s_add_u32 s61, s61, s60
    v_permlane16_swap_b32 v80, v82
    v_permlane16_swap_b32 v81, v83
    buffer_store_dwordx4 v[80:83], v5, s[56:59], s61 offen sc1
    v_pk_fma_f32 v[64:65], v[52:53], v[8:9], v[144:145] op_sel_hi:[1,0,1] neg_lo:[0,1,0] neg_hi:[0,1,0]
    v_pk_fma_f32 v[66:67], v[54:55], v[8:9], v[146:147] op_sel_hi:[1,0,1] neg_lo:[0,1,0] neg_hi:[0,1,0]
    v_pk_fma_f32 v[68:69], v[52:53], v[10:11], v[148:149] op_sel_hi:[1,0,1] neg_lo:[0,1,0] neg_hi:[0,1,0]
    v_pk_fma_f32 v[70:71], v[54:55], v[10:11], v[150:151] op_sel_hi:[1,0,1] neg_lo:[0,1,0] neg_hi:[0,1,0]
    v_pk_mul_f32 v[72:73], v[64:65], v[60:61] op_sel_hi:[1,0]
    v_pk_mul_f32 v[74:75], v[66:67], v[60:61] op_sel_hi:[1,0]
    v_pk_mul_f32 v[76:77], v[68:69], v[62:63] op_sel_hi:[1,0]
    v_pk_mul_f32 v[78:79], v[70:71], v[62:63] op_sel_hi:[1,0]
    v_exp_f32 v72, v72
    v_exp_f32 v73, v73
    v_exp_f32 v74, v74
    v_exp_f32 v75, v75
    v_exp_f32 v76, v76
    v_exp_f32 v77, v77
    v_exp_f32 v78, v78
    v_exp_f32 v79, v79
    v_pk_fma_f32 v[72:73], v[72:73], v[8:9], v[8:9] op_sel:[0,1,1] op_sel_hi:[1,1,1]
    v_pk_fma_f32 v[74:75], v[74:75], v[8:9], v[8:9] op_sel:[0,1,1] op_sel_hi:[1,1,1]
    v_pk_fma_f32 v[76:77], v[76:77], v[10:11], v[10:11] op_sel:[0,1,1] op_sel_hi:[1,1,1]
    v_pk_fma_f32 v[78:79], v[78:79], v[10:11], v[10:11] op_sel:[0,1,1] op_sel_hi:[1,1,1]
    v_rcp_f32 v72, v72
    v_rcp_f32 v73, v73
    v_rcp_f32 v74, v74
    v_rcp_f32 v75, v75
    v_rcp_f32 v76, v76
    v_rcp_f32 v77, v77
    v_rcp_f32 v78, v78
    v_rcp_f32 v79, v79
    v_pk_mul_f32 v[64:65], v[64:65], v[72:73]
    v_pk_mul_f32 v[66:67], v[66:67], v[74:75]
    v_pk_mul_f32 v[68:69], v[68:69], v[76:77]
    v_pk_mul_f32 v[70:71], v[70:71], v[78:79]
    v_cvt_pk_bf16_f32 v84, v64, v65
    v_cvt_pk_bf16_f32 v85, v66, v67
    v_cvt_pk_bf16_f32 v86, v68, v69
    v_cvt_pk_bf16_f32 v87, v70, v71
    s_lshl_b32 s61, s69, 9
    s_add_u32 s61, s61, s60
    v_permlane16_swap_b32 v84, v86
    v_permlane16_swap_b32 v85, v87
    buffer_store_dwordx4 v[84:87], v5, s[56:59], s61 offen sc1
    v_pk_fma_f32 v[64:65], v[56:57], v[8:9], v[152:153] op_sel_hi:[1,0,1] neg_lo:[0,1,0] neg_hi:[0,1,0]
    v_pk_fma_f32 v[66:67], v[58:59], v[8:9], v[154:155] op_sel_hi:[1,0,1] neg_lo:[0,1,0] neg_hi:[0,1,0]
    v_pk_fma_f32 v[68:69], v[56:57], v[10:11], v[156:157] op_sel_hi:[1,0,1] neg_lo:[0,1,0] neg_hi:[0,1,0]
    v_pk_fma_f32 v[70:71], v[58:59], v[10:11], v[158:159] op_sel_hi:[1,0,1] neg_lo:[0,1,0] neg_hi:[0,1,0]
    v_pk_mul_f32 v[72:73], v[64:65], v[60:61] op_sel_hi:[1,0]
    v_pk_mul_f32 v[74:75], v[66:67], v[60:61] op_sel_hi:[1,0]
    v_pk_mul_f32 v[76:77], v[68:69], v[62:63] op_sel_hi:[1,0]
    v_pk_mul_f32 v[78:79], v[70:71], v[62:63] op_sel_hi:[1,0]
    v_exp_f32 v72, v72
    v_exp_f32 v73, v73
    v_exp_f32 v74, v74
    v_exp_f32 v75, v75
    v_exp_f32 v76, v76
    v_exp_f32 v77, v77
    v_exp_f32 v78, v78
    v_exp_f32 v79, v79
    v_pk_fma_f32 v[72:73], v[72:73], v[8:9], v[8:9] op_sel:[0,1,1] op_sel_hi:[1,1,1]
    v_pk_fma_f32 v[74:75], v[74:75], v[8:9], v[8:9] op_sel:[0,1,1] op_sel_hi:[1,1,1]
    v_pk_fma_f32 v[76:77], v[76:77], v[10:11], v[10:11] op_sel:[0,1,1] op_sel_hi:[1,1,1]
    v_pk_fma_f32 v[78:79], v[78:79], v[10:11], v[10:11] op_sel:[0,1,1] op_sel_hi:[1,1,1]
    v_rcp_f32 v72, v72
    v_rcp_f32 v73, v73
    v_rcp_f32 v74, v74
    v_rcp_f32 v75, v75
    v_rcp_f32 v76, v76
    v_rcp_f32 v77, v77
    v_rcp_f32 v78, v78
    v_rcp_f32 v79, v79
    v_pk_mul_f32 v[64:65], v[64:65], v[72:73]
    v_pk_mul_f32 v[66:67], v[66:67], v[74:75]
    v_pk_mul_f32 v[68:69], v[68:69], v[76:77]
    v_pk_mul_f32 v[70:71], v[70:71], v[78:79]
    v_cvt_pk_bf16_f32 v80, v64, v65
    v_cvt_pk_bf16_f32 v81, v66, v67
    v_cvt_pk_bf16_f32 v82, v68, v69
    v_cvt_pk_bf16_f32 v83, v70, v71
    s_lshl_b32 s61, s70, 9
    s_add_u32 s61, s61, s60
    v_permlane16_swap_b32 v80, v82
    v_permlane16_swap_b32 v81, v83
    buffer_store_dwordx4 v[80:83], v5, s[56:59], s61 offen sc1
    v_mov_b32 v128, 0
    v_mov_b32 v129, 0
    v_mov_b32 v130, 0
    v_mov_b32 v131, 0
    v_mov_b32 v132, 0
    v_mov_b32 v133, 0
    v_mov_b32 v134, 0
    v_mov_b32 v135, 0
    v_mov_b32 v136, 0
    v_mov_b32 v137, 0
    v_mov_b32 v138, 0
    v_mov_b32 v139, 0
    v_mov_b32 v140, 0
    v_mov_b32 v141, 0
    v_mov_b32 v142, 0
    v_mov_b32 v143, 0
    v_mov_b32 v144, 0
    v_mov_b32 v145, 0
    v_mov_b32 v146, 0
    v_mov_b32 v147, 0
    v_mov_b32 v148, 0
    v_mov_b32 v149, 0
    v_mov_b32 v150, 0
    v_mov_b32 v151, 0
    v_mov_b32 v152, 0
    v_mov_b32 v153, 0
    v_mov_b32 v154, 0
    v_mov_b32 v155, 0
    v_mov_b32 v156, 0
    v_mov_b32 v157, 0
    v_mov_b32 v158, 0
    v_mov_b32 v159, 0
    s_add_u32 s40, s26, 3145728
    s_addc_u32 s41, s27, 0
    s_mov_b32 s42, 2097152
    s_mov_b32 s43, 0x00020000
    s_mov_b32 s44, s4
    s_mov_b32 s45, s5
    s_mov_b32 s46, 2097152
    s_mov_b32 s47, 0x00020000
    s_mov_b32 s48, s22
    s_mov_b32 s49, s23
    s_mov_b32 s50, 2097152
    s_mov_b32 s51, 0x00020000
    s_lshl_b32 s60, s2, 2
    s_load_dword s79, s[14:15], s60
    s_and_b32 s64, s3, 1
    s_lshr_b32 s65, s3, 1
    s_lshl_b32 s60, s37, 6
    s_lshl_b32 s61, s65, 5
    s_add_u32 s60, s60, s61
    v_add_u32 v13, s60, v3
    v_lshlrev_b32 v192, 3, v13
    s_lshl_b32 s60, s38, 7
    s_lshl_b32 s61, s64, 6
    s_add_u32 s60, s60, s61
    v_lshlrev_b32 v14, 10, v13
    v_add_u32 v14, s60, v14
    v_lshl_add_u32 v198, v4, 3, v14
    v_and_b32 v15, 1, v4
    v_lshl_add_u32 v193, v15, 5, v14
    v_lshrrev_b32 v15, 1, v4
    v_lshl_add_u32 v193, v15, 4, v193
    s_lshl_b32 s60, s65, 12
    v_lshlrev_b32 v15, 4, v2
    v_add_u32 v197, s60, v15
    v_add_u32 v194, 114688, v197
    v_lshrrev_b32 v13, 2, v3
    v_lshl_add_u32 v14, v4, 3, v13
    v_lshlrev_b32 v14, 7, v14
    v_lshrrev_b32 v13, 1, v13
    v_and_b32 v15, 1, v4
    v_lshl_or_b32 v13, v15, 1, v13
    v_lshlrev_b32 v13, 1, v13
    v_and_b32 v15, 3, v3
    v_and_b32 v12, 1, v15
    v_lshl_add_u32 v14, v12, 3, v14
    v_add_u32 v14, 49152, v14
    v_lshrrev_b32 v15, 1, v15
    s_lshl_b32 s60, s64, 2
    s_add_u32 s60, s60, 0
    v_add_u32 v12, s60, v15
    v_xor_b32 v12, v12, v13
    v_lshl_add_u32 v195, v12, 4, v14
    s_lshl_b32 s60, s64, 2
    s_add_u32 s60, s60, 2
    v_add_u32 v12, s60, v15
    v_xor_b32 v12, v12, v13
    v_lshl_add_u32 v196, v12, 4, v14
    v_lshrrev_b32 v13, 2, v3
    v_lshl_add_u32 v13, v4, 2, v13
    s_lshl_b32 s60, s64, 5
    v_add_u32 v13, s60, v13
    v_lshlrev_b32 v13, 7, v13
    v_and_b32 v14, 3, v3
    v_lshl_add_u32 v13, v14, 3, v13
    s_lshl_b32 s60, s65, 6
    s_add_u32 s60, s60, 40960
    v_add_u32 v199, s60, v13
    v_lshlrev_b32 v5, 4, v2
    v_add_u32 v5, 98304, v5
    s_lshl_b32 s60, s3, 12
    v_add_u32 v6, s60, v5
    s_xor_b32 s60, s3, 1
    s_lshl_b32 s60, s60, 12
    v_add_u32 v7, s60, v5
    v_lshlrev_b32 v8, 5, v3
    v_lshl_add_u32 v8, v4, 3, v8
    s_lshl_b32 s60, s71, 12
    s_lshl_b32 s61, s72, 11
    s_sub_u32 s60, s60, s61
    s_add_u32 s60, s60, 2552
    v_sub_u32 v9, s60, v8
    s_lshl_b32 s61, s3, 2
    v_mov_b32 v10, s61
    v_xor_b32 v11, 4, v10
    s_lshl_b32 s76, s2, 1
    s_add_u32 s76, s76, s71
    s_lshl_b32 s76, s76, 12
    s_lshl_b32 s61, s72, 11
    s_add_u32 s76, s76, s61
    s_lshl_b32 s60, s35, 4
    s_add_u32 s60, s60, s36
    s_lshl_b32 s60, s60, 2
    s_add_u32 s60, s60, s3
    s_lshl_b32 s60, s60, 7
    s_add_u32 s60, s60, 131072
    s_waitcnt vmcnt(0)
    s_mov_b32 s61, 16384
    buffer_load_dwordx2 v[200:201], v192, s[28:31], 0 offen sc1
    buffer_load_dwordx2 v[202:203], v192, s[28:31], 0 offen offset:128 sc1
    buffer_load_dwordx2 v[204:205], v198, s[44:47], 0 offen offset:0
    buffer_load_dwordx2 v[206:207], v198, s[44:47], 0 offen offset:32
    buffer_load_dwordx2 v[208:209], v198, s[44:47], s61 offen offset:0
    buffer_load_dwordx2 v[210:211], v198, s[44:47], s61 offen offset:32
    s_waitcnt lgkmcnt(0)
    s_cmp_eq_u32 s71, 0
    s_cselect_b32 s60, 16, 0
    s_lshl_b32 s79, s79, s60
    s_and_b32 s79, s79, 0xffff0000
    s_barrier
    ds_read_b128 v[48:51], v184 offset:3584
    ds_read_b64 v[16:17], v182 offset:0
    ds_read_b64 v[18:19], v183 offset:0
    ds_read_b128 v[52:55], v184 offset:3072
    ds_read_b64 v[20:21], v182 offset:2048
    ds_read_b64 v[22:23], v183 offset:2048
    ds_read_b128 v[56:59], v184 offset:2560
    ds_read_b64 v[24:25], v182 offset:4096
    ds_read_b64 v[26:27], v183 offset:4096
    ds_read_b128 v[60:63], v184 offset:2048
    ds_read_b64 v[28:29], v182 offset:6144
    ds_read_b64 v[30:31], v183 offset:6144
    ds_read_b128 v[64:67], v184 offset:1536
    ds_read_b64 v[32:33], v182 offset:8192
    ds_read_b64 v[34:35], v183 offset:8192
    ds_read_b128 v[68:71], v184 offset:1024
    ds_read_b64 v[36:37], v182 offset:10240
    ds_read_b64 v[38:39], v183 offset:10240
    ds_read_b128 v[72:75], v184 offset:512
    ds_read_b64 v[40:41], v182 offset:12288
    ds_read_b64 v[42:43], v183 offset:12288
    ds_read_b128 v[76:79], v184 offset:0
    ds_read_b64 v[44:45], v182 offset:14336
    ds_read_b64 v[46:47], v183 offset:14336
    v_add_u32 v182, 256, v182
    v_add_u32 v183, 256, v183
    v_add_u32 v184, 64, v184
    s_mov_b32 s60, 0
    s_waitcnt lgkmcnt(0)
    v_and_b32 v16, v185, v16
    v_and_b32 v17, v185, v17
    v_and_b32 v18, v186, v18
    v_and_b32 v19, v186, v19
    v_cmp_gt_i32 vcc, 32, v187
    v_mov_b32 v185, -1
    v_mov_b32 v186, -1
    v_cndmask_b32 v48, 0, v48, vcc
    v_cndmask_b32 v49, 0, v49, vcc
    v_cndmask_b32 v50, 0, v50, vcc
    v_cndmask_b32 v51, 0, v51, vcc
    v_add_u32 v187, 64, v187
    s_nop 0
L_cloop:
    s_waitcnt lgkmcnt(0)
    v_mfma_f32_16x16x32_bf16 v[128:131], v[16:19], v[48:51], v[128:131]
    ds_read_b128 v[112:115], v184 offset:3584
    v_mfma_f32_16x16x32_bf16 v[132:135], v[20:23], v[48:51], v[132:135]
    ds_read_b64 v[80:81], v182 offset:0
    v_mfma_f32_16x16x32_bf16 v[136:139], v[24:27], v[48:51], v[136:139]
    ds_read_b64 v[82:83], v183 offset:0
    v_mfma_f32_16x16x32_bf16 v[140:143], v[28:31], v[48:51], v[140:143]
    ds_read_b128 v[116:119], v184 offset:3072
    v_mfma_f32_16x16x32_bf16 v[144:147], v[32:35], v[48:51], v[144:147]
    ds_read_b64 v[84:85], v182 offset:2048
    v_mfma_f32_16x16x32_bf16 v[148:151], v[36:39], v[48:51], v[148:151]
    ds_read_b64 v[86:87], v183 offset:2048
    v_mfma_f32_16x16x32_bf16 v[152:155], v[40:43], v[48:51], v[152:155]
    ds_read_b128 v[120:123], v184 offset:2560
    v_mfma_f32_16x16x32_bf16 v[156:159], v[44:47], v[48:51], v[156:159]
    ds_read_b64 v[88:89], v182 offset:4096
    v_mfma_f32_16x16x32_bf16 v[132:135], v[16:19], v[52:55], v[132:135]
    ds_read_b64 v[90:91], v183 offset:4096
    v_mfma_f32_16x16x32_bf16 v[136:139], v[20:23], v[52:55], v[136:139]
    ds_read_b128 v[124:127], v184 offset:2048
    v_mfma_f32_16x16x32_bf16 v[140:143], v[24:27], v[52:55], v[140:143]
    ds_read_b64 v[92:93], v182 offset:6144
    v_mfma_f32_16x16x32_bf16 v[144:147], v[28:31], v[52:55], v[144:147]
    ds_read_b64 v[94:95], v183 offset:6144
    v_mfma_f32_16x16x32_bf16 v[148:151], v[32:35], v[52:55], v[148:151]
    ds_read_b128 v[166:169], v184 offset:1536
    s_waitcnt lgkmcnt(10)
    v_and_b32 v80, v185, v80
    v_mfma_f32_16x16x32_bf16 v[152:155], v[36:39], v[52:55], v[152:155]
    ds_read_b64 v[96:97], v182 offset:8192
    v_and_b32 v81, v185, v81
    v_mfma_f32_16x16x32_bf16 v[156:159], v[40:43], v[52:55], v[156:159]
    ds_read_b64 v[98:99], v183 offset:8192
    v_and_b32 v82, v186, v82
    v_mfma_f32_16x16x32_bf16 v[136:139], v[16:19], v[56:59], v[136:139]
    ds_read_b128 v[170:173], v184 offset:1024
    v_and_b32 v83, v186, v83
    v_mfma_f32_16x16x32_bf16 v[140:143], v[20:23], v[56:59], v[140:143]
    ds_read_b64 v[100:101], v182 offset:10240
    v_cmp_gt_i32 vcc, 32, v187
    v_mfma_f32_16x16x32_bf16 v[144:147], v[24:27], v[56:59], v[144:147]
    ds_read_b64 v[102:103], v183 offset:10240
    v_mov_b32 v185, -1
    v_mfma_f32_16x16x32_bf16 v[148:151], v[28:31], v[56:59], v[148:151]
    ds_read_b128 v[174:177], v184 offset:512
    v_mov_b32 v186, -1
    v_mfma_f32_16x16x32_bf16 v[152:155], v[32:35], v[56:59], v[152:155]
    ds_read_b64 v[104:105], v182 offset:12288
    v_cndmask_b32 v112, 0, v112, vcc
    v_mfma_f32_16x16x32_bf16 v[156:159], v[36:39], v[56:59], v[156:159]
    ds_read_b64 v[106:107], v183 offset:12288
    v_cndmask_b32 v113, 0, v113, vcc
    v_mfma_f32_16x16x32_bf16 v[140:143], v[16:19], v[60:63], v[140:143]
    ds_read_b128 v[178:181], v184 offset:0
    v_cndmask_b32 v114, 0, v114, vcc
    v_mfma_f32_16x16x32_bf16 v[144:147], v[20:23], v[60:63], v[144:147]
    ds_read_b64 v[108:109], v182 offset:14336
    v_cndmask_b32 v115, 0, v115, vcc
    v_mfma_f32_16x16x32_bf16 v[148:151], v[24:27], v[60:63], v[148:151]
    ds_read_b64 v[110:111], v183 offset:14336
    v_add_u32 v187, 64, v187
    v_mfma_f32_16x16x32_bf16 v[152:155], v[28:31], v[60:63], v[152:155]
    v_mfma_f32_16x16x32_bf16 v[156:159], v[32:35], v[60:63], v[156:159]
    v_mfma_f32_16x16x32_bf16 v[144:147], v[16:19], v[64:67], v[144:147]
    v_mfma_f32_16x16x32_bf16 v[148:151], v[20:23], v[64:67], v[148:151]
    v_mfma_f32_16x16x32_bf16 v[152:155], v[24:27], v[64:67], v[152:155]
    v_mfma_f32_16x16x32_bf16 v[156:159], v[28:31], v[64:67], v[156:159]
    v_mfma_f32_16x16x32_bf16 v[148:151], v[16:19], v[68:71], v[148:151]
    v_mfma_f32_16x16x32_bf16 v[152:155], v[20:23], v[68:71], v[152:155]
    v_mfma_f32_16x16x32_bf16 v[156:159], v[24:27], v[68:71], v[156:159]
    v_mfma_f32_16x16x32_bf16 v[152:155], v[16:19], v[72:75], v[152:155]
    v_mfma_f32_16x16x32_bf16 v[156:159], v[20:23], v[72:75], v[156:159]
    v_mfma_f32_16x16x32_bf16 v[156:159], v[16:19], v[76:79], v[156:159]
    v_add_u32 v182, 256, v182
    v_add_u32 v183, 256, v183
    v_add_u32 v184, 64, v184
    s_waitcnt lgkmcnt(0)
    v_mfma_f32_16x16x32_bf16 v[128:131], v[80:83], v[112:115], v[128:131]
    ds_read_b128 v[48:51], v184 offset:3584
    v_mfma_f32_16x16x32_bf16 v[132:135], v[84:87], v[112:115], v[132:135]
    ds_read_b64 v[16:17], v182 offset:0
    v_mfma_f32_16x16x32_bf16 v[136:139], v[88:91], v[112:115], v[136:139]
    ds_read_b64 v[18:19], v183 offset:0
    v_mfma_f32_16x16x32_bf16 v[140:143], v[92:95], v[112:115], v[140:143]
    ds_read_b128 v[52:55], v184 offset:3072
    v_mfma_f32_16x16x32_bf16 v[144:147], v[96:99], v[112:115], v[144:147]
    ds_read_b64 v[20:21], v182 offset:2048
    v_mfma_f32_16x16x32_bf16 v[148:151], v[100:103], v[112:115], v[148:151]
    ds_read_b64 v[22:23], v183 offset:2048
    v_mfma_f32_16x16x32_bf16 v[152:155], v[104:107], v[112:115], v[152:155]
    ds_read_b128 v[56:59], v184 offset:2560
    v_mfma_f32_16x16x32_bf16 v[156:159], v[108:111], v[112:115], v[156:159]
    ds_read_b64 v[24:25], v182 offset:4096
    v_mfma_f32_16x16x32_bf16 v[132:135], v[80:83], v[116:119], v[132:135]
    ds_read_b64 v[26:27], v183 offset:4096
    v_mfma_f32_16x16x32_bf16 v[136:139], v[84:87], v[116:119], v[136:139]
    ds_read_b128 v[60:63], v184 offset:2048
    v_mfma_f32_16x16x32_bf16 v[140:143], v[88:91], v[116:119], v[140:143]
    ds_read_b64 v[28:29], v182 offset:6144
    v_mfma_f32_16x16x32_bf16 v[144:147], v[92:95], v[116:119], v[144:147]
    ds_read_b64 v[30:31], v183 offset:6144
    v_mfma_f32_16x16x32_bf16 v[148:151], v[96:99], v[116:119], v[148:151]
    ds_read_b128 v[64:67], v184 offset:1536
    s_waitcnt lgkmcnt(10)
    v_and_b32 v16, v185, v16
    v_mfma_f32_16x16x32_bf16 v[152:155], v[100:103], v[116:119], v[152:155]
    ds_read_b64 v[32:33], v182 offset:8192
    v_and_b32 v17, v185, v17
    v_mfma_f32_16x16x32_bf16 v[156:159], v[104:107], v[116:119], v[156:159]
    ds_read_b64 v[34:35], v183 offset:8192
    v_and_b32 v18, v186, v18
    v_mfma_f32_16x16x32_bf16 v[136:139], v[80:83], v[120:123], v[136:139]
    ds_read_b128 v[68:71], v184 offset:1024
    v_and_b32 v19, v186, v19
    v_mfma_f32_16x16x32_bf16 v[140:143], v[84:87], v[120:123], v[140:143]
    ds_read_b64 v[36:37], v182 offset:10240
    v_cmp_gt_i32 vcc, 32, v187
    v_mfma_f32_16x16x32_bf16 v[144:147], v[88:91], v[120:123], v[144:147]
    ds_read_b64 v[38:39], v183 offset:10240
    v_mov_b32 v185, -1
    v_mfma_f32_16x16x32_bf16 v[148:151], v[92:95], v[120:123], v[148:151]
    ds_read_b128 v[72:75], v184 offset:512
    v_mov_b32 v186, -1
    v_mfma_f32_16x16x32_bf16 v[152:155], v[96:99], v[120:123], v[152:155]
    ds_read_b64 v[40:41], v182 offset:12288
    v_cndmask_b32 v48, 0, v48, vcc
    v_mfma_f32_16x16x32_bf16 v[156:159], v[100:103], v[120:123], v[156:159]
    ds_read_b64 v[42:43], v183 offset:12288
    v_cndmask_b32 v49, 0, v49, vcc
    v_mfma_f32_16x16x32_bf16 v[140:143], v[80:83], v[124:127], v[140:143]
    ds_read_b128 v[76:79], v184 offset:0
    v_cndmask_b32 v50, 0, v50, vcc
    v_mfma_f32_16x16x32_bf16 v[144:147], v[84:87], v[124:127], v[144:147]
    ds_read_b64 v[44:45], v182 offset:14336
    v_cndmask_b32 v51, 0, v51, vcc
    v_mfma_f32_16x16x32_bf16 v[148:151], v[88:91], v[124:127], v[148:151]
    ds_read_b64 v[46:47], v183 offset:14336
    v_add_u32 v187, 64, v187
    v_mfma_f32_16x16x32_bf16 v[152:155], v[92:95], v[124:127], v[152:155]
    v_mfma_f32_16x16x32_bf16 v[156:159], v[96:99], v[124:127], v[156:159]
    v_mfma_f32_16x16x32_bf16 v[144:147], v[80:83], v[166:169], v[144:147]
    v_mfma_f32_16x16x32_bf16 v[148:151], v[84:87], v[166:169], v[148:151]
    v_mfma_f32_16x16x32_bf16 v[152:155], v[88:91], v[166:169], v[152:155]
    v_mfma_f32_16x16x32_bf16 v[156:159], v[92:95], v[166:169], v[156:159]
    v_mfma_f32_16x16x32_bf16 v[148:151], v[80:83], v[170:173], v[148:151]
    v_mfma_f32_16x16x32_bf16 v[152:155], v[84:87], v[170:173], v[152:155]
    v_mfma_f32_16x16x32_bf16 v[156:159], v[88:91], v[170:173], v[156:159]
    v_mfma_f32_16x16x32_bf16 v[152:155], v[80:83], v[174:177], v[152:155]
    v_mfma_f32_16x16x32_bf16 v[156:159], v[84:87], v[174:177], v[156:159]
    v_mfma_f32_16x16x32_bf16 v[156:159], v[80:83], v[178:181], v[156:159]
    v_add_u32 v182, 256, v182
    v_add_u32 v183, 256, v183
    v_add_u32 v184, 64, v184
    s_add_u32 s60, s60, 1
    s_cmp_lt_u32 s60, 2
    s_cbranch_scc1 L_cloop
    s_waitcnt lgkmcnt(0)
    s_nop 4
    s_cmp_eq_u32 s72, 0
    s_cbranch_scc1 L_nosw_4
    v_swap_b32 v128, v144
    v_swap_b32 v129, v145
    v_swap_b32 v130, v146
    v_swap_b32 v131, v147
    v_swap_b32 v132, v148
    v_swap_b32 v133, v149
    v_swap_b32 v134, v150
    v_swap_b32 v135, v151
    v_swap_b32 v136, v152
    v_swap_b32 v137, v153
    v_swap_b32 v138, v154
    v_swap_b32 v139, v155
    v_swap_b32 v140, v156
    v_swap_b32 v141, v157
    v_swap_b32 v142, v158
    v_swap_b32 v143, v159
L_nosw_4:
    ds_read_b64 v[16:17], v9 offset:1536
    ds_read_b64 v[18:19], v9 offset:1024
    ds_read_b64 v[20:21], v9 offset:512
    ds_read_b64 v[22:23], v9 offset:0
    ds_write_b128 v6, v[144:147] offset:0
    ds_write_b128 v6, v[148:151] offset:1024
    ds_write_b128 v6, v[152:155] offset:2048
    ds_write_b128 v6, v[156:159] offset:3072
    v_mov_b32 v12, 1
    s_waitcnt lgkmcnt(0)
    ds_write_b32 v10, v12 offset:42496
    s_mov_b32 s39, 200000
L_lsp_5:
    ds_read_b32 v12, v11 offset:42496
    s_waitcnt lgkmcnt(0)
    v_readfirstlane_b32 s61, v12
    s_nop 3
    s_cmp_eq_u32 s61, 1
    s_cbranch_scc1 L_lsd_6
    s_sub_u32 s39, s39, 1
    s_cbranch_scc0 L_lsp_5
L_lsd_6:
    ds_read_b128 v[32:35], v7 offset:0
    ds_read_b128 v[36:39], v7 offset:1024
    ds_read_b128 v[40:43], v7 offset:2048
    ds_read_b128 v[44:47], v7 offset:3072
    v_and_b32 v48, 0xffff0000, v17
    v_lshlrev_b32 v49, 16, v17
    v_and_b32 v50, 0xffff0000, v16
    v_lshlrev_b32 v51, 16, v16
    v_fmac_f32 v128, s79, v48
    v_fmac_f32 v129, s79, v49
    v_fmac_f32 v130, s79, v50
    v_fmac_f32 v131, s79, v51
    v_and_b32 v48, 0xffff0000, v19
    v_lshlrev_b32 v49, 16, v19
    v_and_b32 v50, 0xffff0000, v18
    v_lshlrev_b32 v51, 16, v18
    v_fmac_f32 v132, s79, v48
    v_fmac_f32 v133, s79, v49
    v_fmac_f32 v134, s79, v50
    v_fmac_f32 v135, s79, v51
    v_and_b32 v48, 0xffff0000, v21
    v_lshlrev_b32 v49, 16, v21
    v_and_b32 v50, 0xffff0000, v20
    v_lshlrev_b32 v51, 16, v20
    v_fmac_f32 v136, s79, v48
    v_fmac_f32 v137, s79, v49
    v_fmac_f32 v138, s79, v50
    v_fmac_f32 v139, s79, v51
    v_and_b32 v48, 0xffff0000, v23
    v_lshlrev_b32 v49, 16, v23
    v_and_b32 v50, 0xffff0000, v22
    v_lshlrev_b32 v51, 16, v22
    v_fmac_f32 v140, s79, v48
    v_fmac_f32 v141, s79, v49
    v_fmac_f32 v142, s79, v50
    v_fmac_f32 v143, s79, v51
    s_waitcnt lgkmcnt(0)
    v_add_f32 v128, v128, v32
    v_add_f32 v129, v129, v33
    v_add_f32 v130, v130, v34
    v_add_f32 v131, v131, v35
    v_cvt_pk_bf16_f32 v52, v128, v129
    v_cvt_pk_bf16_f32 v53, v130, v131
    v_add_f32 v132, v132, v36
    v_add_f32 v133, v133, v37
    v_add_f32 v134, v134, v38
    v_add_f32 v135, v135, v39
    v_cvt_pk_bf16_f32 v54, v132, v133
    v_cvt_pk_bf16_f32 v55, v134, v135
    v_add_f32 v136, v136, v40
    v_add_f32 v137, v137, v41
    v_add_f32 v138, v138, v42
    v_add_f32 v139, v139, v43
    v_cvt_pk_bf16_f32 v56, v136, v137
    v_cvt_pk_bf16_f32 v57, v138, v139
    v_add_f32 v140, v140, v44
    v_add_f32 v141, v141, v45
    v_add_f32 v142, v142, v46
    v_add_f32 v143, v143, v47
    v_cvt_pk_bf16_f32 v58, v140, v141
    v_cvt_pk_bf16_f32 v59, v142, v143
    ds_write_b128 v7, v[52:55]
    ds_write_b128 v7, v[56:59] offset:1024
    s_waitcnt lgkmcnt(0)
    v_mov_b32 v64, 0
    v_mov_b32 v65, 0
    v_mov_b32 v66, 0
    v_mov_b32 v67, 0
    v_mov_b32 v68, 0
    v_mov_b32 v69, 0
    v_mov_b32 v70, 0
    v_mov_b32 v71, 0
    v_mov_b32 v72, 0
    v_mov_b32 v73, 0
    v_mov_b32 v74, 0
    v_mov_b32 v75, 0
    v_mov_b32 v76, 0
    v_mov_b32 v77, 0
    v_mov_b32 v78, 0
    v_mov_b32 v79, 0
    s_mov_b32 s60, 0
    s_barrier
    ds_read_b64_tr_b16 v[32:33], v195 offset:0
    ds_read_b64_tr_b16 v[34:35], v195 offset:512
    ds_read_b64_tr_b16 v[36:37], v196 offset:0
    ds_read_b64_tr_b16 v[38:39], v196 offset:512
    ds_read_b128 v[48:51], v194 offset:0
    ds_read_b128 v[52:55], v194 offset:2048
    ds_read_b64_tr_b16 v[40:41], v195 offset:4096
    ds_read_b64_tr_b16 v[42:43], v195 offset:4608
    ds_read_b64_tr_b16 v[44:45], v196 offset:4096
    ds_read_b64_tr_b16 v[46:47], v196 offset:4608
    ds_read_b128 v[56:59], v194 offset:1024
    ds_read_b128 v[60:63], v194 offset:3072
L_g2loop:
    s_waitcnt lgkmcnt(6)
    v_mfma_f32_16x16x32_bf16 v[64:67], v[32:35], v[48:51], v[64:67]
    ds_read_b64_tr_b16 v[96:97], v195 offset:8192
    ds_read_b64_tr_b16 v[98:99], v195 offset:8704
    v_mfma_f32_16x16x32_bf16 v[68:71], v[32:35], v[52:55], v[68:71]
    ds_read_b64_tr_b16 v[100:101], v196 offset:8192
    ds_read_b64_tr_b16 v[102:103], v196 offset:8704
    v_mfma_f32_16x16x32_bf16 v[72:75], v[36:39], v[48:51], v[72:75]
    ds_read_b128 v[112:115], v194 offset:8192
    ds_read_b128 v[116:119], v194 offset:10240
    v_mfma_f32_16x16x32_bf16 v[76:79], v[36:39], v[52:55], v[76:79]
    s_waitcnt lgkmcnt(6)
    v_mfma_f32_16x16x32_bf16 v[64:67], v[40:43], v[56:59], v[64:67]
    ds_read_b64_tr_b16 v[104:105], v195 offset:12288
    ds_read_b64_tr_b16 v[106:107], v195 offset:12800
    v_mfma_f32_16x16x32_bf16 v[68:71], v[40:43], v[60:63], v[68:71]
    ds_read_b64_tr_b16 v[108:109], v196 offset:12288
    ds_read_b64_tr_b16 v[110:111], v196 offset:12800
    v_mfma_f32_16x16x32_bf16 v[72:75], v[44:47], v[56:59], v[72:75]
    ds_read_b128 v[120:123], v194 offset:9216
    ds_read_b128 v[124:127], v194 offset:11264
    v_mfma_f32_16x16x32_bf16 v[76:79], v[44:47], v[60:63], v[76:79]
    s_barrier
    s_waitcnt lgkmcnt(6)
    v_mfma_f32_16x16x32_bf16 v[64:67], v[96:99], v[112:115], v[64:67]
    ds_read_b64_tr_b16 v[32:33], v195 offset:16384
    ds_read_b64_tr_b16 v[34:35], v195 offset:16896
    v_mfma_f32_16x16x32_bf16 v[68:71], v[96:99], v[116:119], v[68:71]
    ds_read_b64_tr_b16 v[36:37], v196 offset:16384
    ds_read_b64_tr_b16 v[38:39], v196 offset:16896
    v_mfma_f32_16x16x32_bf16 v[72:75], v[100:103], v[112:115], v[72:75]
    ds_read_b128 v[48:51], v194 offset:16384
    ds_read_b128 v[52:55], v194 offset:18432
    v_mfma_f32_16x16x32_bf16 v[76:79], v[100:103], v[116:119], v[76:79]
    s_waitcnt lgkmcnt(6)
    v_mfma_f32_16x16x32_bf16 v[64:67], v[104:107], v[120:123], v[64:67]
    ds_read_b64_tr_b16 v[40:41], v195 offset:20480
    ds_read_b64_tr_b16 v[42:43], v195 offset:20992
    v_mfma_f32_16x16x32_bf16 v[68:71], v[104:107], v[124:127], v[68:71]
    ds_read_b64_tr_b16 v[44:45], v196 offset:20480
    ds_read_b64_tr_b16 v[46:47], v196 offset:20992
    v_mfma_f32_16x16x32_bf16 v[72:75], v[108:111], v[120:123], v[72:75]
    ds_read_b128 v[56:59], v194 offset:17408
    ds_read_b128 v[60:63], v194 offset:19456
    v_mfma_f32_16x16x32_bf16 v[76:79], v[108:111], v[124:127], v[76:79]
    s_barrier
    s_waitcnt lgkmcnt(6)
    v_mfma_f32_16x16x32_bf16 v[64:67], v[32:35], v[48:51], v[64:67]
    ds_read_b64_tr_b16 v[96:97], v195 offset:24576
    ds_read_b64_tr_b16 v[98:99], v195 offset:25088
    v_mfma_f32_16x16x32_bf16 v[68:71], v[32:35], v[52:55], v[68:71]
    ds_read_b64_tr_b16 v[100:101], v196 offset:24576
    ds_read_b64_tr_b16 v[102:103], v196 offset:25088
    v_mfma_f32_16x16x32_bf16 v[72:75], v[36:39], v[48:51], v[72:75]
    ds_read_b128 v[112:115], v194 offset:24576
    ds_read_b128 v[116:119], v194 offset:26624
    v_mfma_f32_16x16x32_bf16 v[76:79], v[36:39], v[52:55], v[76:79]
    s_waitcnt lgkmcnt(6)
    v_mfma_f32_16x16x32_bf16 v[64:67], v[40:43], v[56:59], v[64:67]
    ds_read_b64_tr_b16 v[104:105], v195 offset:28672
    ds_read_b64_tr_b16 v[106:107], v195 offset:29184
    v_mfma_f32_16x16x32_bf16 v[68:71], v[40:43], v[60:63], v[68:71]
    ds_read_b64_tr_b16 v[108:109], v196 offset:28672
    ds_read_b64_tr_b16 v[110:111], v196 offset:29184
    v_mfma_f32_16x16x32_bf16 v[72:75], v[44:47], v[56:59], v[72:75]
    ds_read_b128 v[120:123], v194 offset:25600
    ds_read_b128 v[124:127], v194 offset:27648
    v_mfma_f32_16x16x32_bf16 v[76:79], v[44:47], v[60:63], v[76:79]
    s_barrier
    s_waitcnt lgkmcnt(6)
    v_mfma_f32_16x16x32_bf16 v[64:67], v[96:99], v[112:115], v[64:67]
    ds_read_b64_tr_b16 v[32:33], v195 offset:32768
    ds_read_b64_tr_b16 v[34:35], v195 offset:33280
    v_mfma_f32_16x16x32_bf16 v[68:71], v[96:99], v[116:119], v[68:71]
    ds_read_b64_tr_b16 v[36:37], v196 offset:32768
    ds_read_b64_tr_b16 v[38:39], v196 offset:33280
    v_mfma_f32_16x16x32_bf16 v[72:75], v[100:103], v[112:115], v[72:75]
    ds_read_b128 v[48:51], v194 offset:32768
    ds_read_b128 v[52:55], v194 offset:34816
    v_mfma_f32_16x16x32_bf16 v[76:79], v[100:103], v[116:119], v[76:79]
    s_waitcnt lgkmcnt(6)
    v_mfma_f32_16x16x32_bf16 v[64:67], v[104:107], v[120:123], v[64:67]
    ds_read_b64_tr_b16 v[40:41], v195 offset:36864
    ds_read_b64_tr_b16 v[42:43], v195 offset:37376
    v_mfma_f32_16x16x32_bf16 v[68:71], v[104:107], v[124:127], v[68:71]
    ds_read_b64_tr_b16 v[44:45], v196 offset:36864
    ds_read_b64_tr_b16 v[46:47], v196 offset:37376
    v_mfma_f32_16x16x32_bf16 v[72:75], v[108:111], v[120:123], v[72:75]
    ds_read_b128 v[56:59], v194 offset:33792
    ds_read_b128 v[60:63], v194 offset:35840
    v_mfma_f32_16x16x32_bf16 v[76:79], v[108:111], v[124:127], v[76:79]
    s_barrier
    s_cmp_eq_u32 s60, 3
    s_cbranch_scc1 L_g2done
    s_waitcnt lgkmcnt(6)
    v_mfma_f32_16x16x32_bf16 v[64:67], v[32:35], v[48:51], v[64:67]
    ds_read_b64_tr_b16 v[96:97], v195 offset:40960
    ds_read_b64_tr_b16 v[98:99], v195 offset:41472
    v_mfma_f32_16x16x32_bf16 v[68:71], v[32:35], v[52:55], v[68:71]
    ds_read_b64_tr_b16 v[100:101], v196 offset:40960
    ds_read_b64_tr_b16 v[102:103], v196 offset:41472
    v_mfma_f32_16x16x32_bf16 v[72:75], v[36:39], v[48:51], v[72:75]
    ds_read_b128 v[112:115], v194 offset:40960
    ds_read_b128 v[116:119], v194 offset:43008
    v_mfma_f32_16x16x32_bf16 v[76:79], v[36:39], v[52:55], v[76:79]
    s_waitcnt lgkmcnt(6)
    v_mfma_f32_16x16x32_bf16 v[64:67], v[40:43], v[56:59], v[64:67]
    ds_read_b64_tr_b16 v[104:105], v195 offset:45056
    ds_read_b64_tr_b16 v[106:107], v195 offset:45568
    v_mfma_f32_16x16x32_bf16 v[68:71], v[40:43], v[60:63], v[68:71]
    ds_read_b64_tr_b16 v[108:109], v196 offset:45056
    ds_read_b64_tr_b16 v[110:111], v196 offset:45568
    v_mfma_f32_16x16x32_bf16 v[72:75], v[44:47], v[56:59], v[72:75]
    ds_read_b128 v[120:123], v194 offset:41984
    ds_read_b128 v[124:127], v194 offset:44032
    v_mfma_f32_16x16x32_bf16 v[76:79], v[44:47], v[60:63], v[76:79]
    s_barrier
    s_waitcnt lgkmcnt(6)
    v_mfma_f32_16x16x32_bf16 v[64:67], v[96:99], v[112:115], v[64:67]
    ds_read_b64_tr_b16 v[32:33], v195 offset:49152
    ds_read_b64_tr_b16 v[34:35], v195 offset:49664
    v_mfma_f32_16x16x32_bf16 v[68:71], v[96:99], v[116:119], v[68:71]
    ds_read_b64_tr_b16 v[36:37], v196 offset:49152
    ds_read_b64_tr_b16 v[38:39], v196 offset:49664
    v_mfma_f32_16x16x32_bf16 v[72:75], v[100:103], v[112:115], v[72:75]
    ds_read_b128 v[48:51], v197 offset:0
    ds_read_b128 v[52:55], v197 offset:2048
    v_mfma_f32_16x16x32_bf16 v[76:79], v[100:103], v[116:119], v[76:79]
    s_waitcnt lgkmcnt(6)
    v_mfma_f32_16x16x32_bf16 v[64:67], v[104:107], v[120:123], v[64:67]
    ds_read_b64_tr_b16 v[40:41], v195 offset:53248
    ds_read_b64_tr_b16 v[42:43], v195 offset:53760
    v_mfma_f32_16x16x32_bf16 v[68:71], v[104:107], v[124:127], v[68:71]
    ds_read_b64_tr_b16 v[44:45], v196 offset:53248
    ds_read_b64_tr_b16 v[46:47], v196 offset:53760
    v_mfma_f32_16x16x32_bf16 v[72:75], v[108:111], v[120:123], v[72:75]
    ds_read_b128 v[56:59], v197 offset:1024
    ds_read_b128 v[60:63], v197 offset:3072
    v_mfma_f32_16x16x32_bf16 v[76:79], v[108:111], v[124:127], v[76:79]
    s_barrier
    s_waitcnt lgkmcnt(6)
    v_mfma_f32_16x16x32_bf16 v[64:67], v[32:35], v[48:51], v[64:67]
    ds_read_b64_tr_b16 v[96:97], v195 offset:57344
    ds_read_b64_tr_b16 v[98:99], v195 offset:57856
    v_mfma_f32_16x16x32_bf16 v[68:71], v[32:35], v[52:55], v[68:71]
    ds_read_b64_tr_b16 v[100:101], v196 offset:57344
    ds_read_b64_tr_b16 v[102:103], v196 offset:57856
    v_mfma_f32_16x16x32_bf16 v[72:75], v[36:39], v[48:51], v[72:75]
    ds_read_b128 v[112:115], v197 offset:8192
    ds_read_b128 v[116:119], v197 offset:10240
    v_mfma_f32_16x16x32_bf16 v[76:79], v[36:39], v[52:55], v[76:79]
    s_waitcnt lgkmcnt(6)
    v_mfma_f32_16x16x32_bf16 v[64:67], v[40:43], v[56:59], v[64:67]
    ds_read_b64_tr_b16 v[104:105], v195 offset:61440
    ds_read_b64_tr_b16 v[106:107], v195 offset:61952
    v_mfma_f32_16x16x32_bf16 v[68:71], v[40:43], v[60:63], v[68:71]
    ds_read_b64_tr_b16 v[108:109], v196 offset:61440
    ds_read_b64_tr_b16 v[110:111], v196 offset:61952
    v_mfma_f32_16x16x32_bf16 v[72:75], v[44:47], v[56:59], v[72:75]
    ds_read_b128 v[120:123], v197 offset:9216
    ds_read_b128 v[124:127], v197 offset:11264
    v_mfma_f32_16x16x32_bf16 v[76:79], v[44:47], v[60:63], v[76:79]
    s_barrier
    s_waitcnt lgkmcnt(6)
    v_mfma_f32_16x16x32_bf16 v[64:67], v[96:99], v[112:115], v[64:67]
    ds_read_b64_tr_b16 v[32:33], v195 offset:0
    ds_read_b64_tr_b16 v[34:35], v195 offset:512
    v_mfma_f32_16x16x32_bf16 v[68:71], v[96:99], v[116:119], v[68:71]
    ds_read_b64_tr_b16 v[36:37], v196 offset:0
    ds_read_b64_tr_b16 v[38:39], v196 offset:512
    v_mfma_f32_16x16x32_bf16 v[72:75], v[100:103], v[112:115], v[72:75]
    ds_read_b128 v[48:51], v194 offset:0
    ds_read_b128 v[52:55], v194 offset:2048
    v_mfma_f32_16x16x32_bf16 v[76:79], v[100:103], v[116:119], v[76:79]
    s_waitcnt lgkmcnt(6)
    v_mfma_f32_16x16x32_bf16 v[64:67], v[104:107], v[120:123], v[64:67]
    ds_read_b64_tr_b16 v[40:41], v195 offset:4096
    ds_read_b64_tr_b16 v[42:43], v195 offset:4608
    v_mfma_f32_16x16x32_bf16 v[68:71], v[104:107], v[124:127], v[68:71]
    ds_read_b64_tr_b16 v[44:45], v196 offset:4096
    ds_read_b64_tr_b16 v[46:47], v196 offset:4608
    v_mfma_f32_16x16x32_bf16 v[72:75], v[108:111], v[120:123], v[72:75]
    ds_read_b128 v[56:59], v194 offset:1024
    ds_read_b128 v[60:63], v194 offset:3072
    v_mfma_f32_16x16x32_bf16 v[76:79], v[108:111], v[124:127], v[76:79]
    s_barrier
    s_add_u32 s60, s60, 1
    s_branch L_g2loop
L_g2done:
    s_waitcnt lgkmcnt(0)
    ds_read_b64_tr_b16 v[128:129], v199 offset:0
    ds_read_b64_tr_b16 v[130:131], v199 offset:2048
    ds_read_b64_tr_b16 v[132:133], v199 offset:32
    ds_read_b64_tr_b16 v[134:135], v199 offset:2080
    s_waitcnt vmcnt(0)
    s_mov_b32 s39, 200000
L_stp_7:
    v_cmp_ne_u32 vcc, s32, v201
    v_cmp_ne_u32 s[60:61], s32, v203
    s_nop 1
    s_or_b64 vcc, vcc, s[60:61]
    s_cbranch_vccz L_std_8
    s_sub_u32 s39, s39, 1
    s_cbranch_scc1 L_std_8
    buffer_load_dwordx2 v[200:201], v192, s[28:31], 0 offen sc1
    buffer_load_dwordx2 v[202:203], v192, s[28:31], 0 offen offset:128 sc1
    s_waitcnt vmcnt(0)
    s_branch L_stp_7
L_std_8:
    v_and_b32 v201, 0xffff0000, v200
    v_lshlrev_b32 v200, 16, v200
    v_and_b32 v203, 0xffff0000, v202
    v_lshlrev_b32 v202, 16, v202
    v_rcp_f32 v40, v201
    v_rcp_f32 v42, v203
    s_waitcnt lgkmcnt(0)
    s_mov_b32 s61, 16384
    v_lshlrev_b32 v44, 16, v204
    v_and_b32 v45, 0xffff0000, v204
    v_lshlrev_b32 v46, 16, v205
    v_and_b32 v47, 0xffff0000, v205
    v_lshlrev_b32 v48, 16, v128
    v_and_b32 v49, 0xffff0000, v128
    v_lshlrev_b32 v50, 16, v129
    v_and_b32 v51, 0xffff0000, v129
    v_pk_add_f32 v[64:65], v[64:65], v[44:45]
    v_pk_add_f32 v[44:45], v[44:45], v[200:201] op_sel_hi:[1,0] neg_lo:[0,1] neg_hi:[0,1]
    v_pk_mul_f32 v[48:49], v[48:49], v[40:41] op_sel_hi:[1,0]
    v_pk_fma_f32 v[64:65], v[44:45], v[48:49], v[64:65]
    v_cvt_pk_bf16_f32 v52, v64, v65
    v_pk_add_f32 v[66:67], v[66:67], v[46:47]
    v_pk_add_f32 v[46:47], v[46:47], v[200:201] op_sel_hi:[1,0] neg_lo:[0,1] neg_hi:[0,1]
    v_pk_mul_f32 v[50:51], v[50:51], v[40:41] op_sel_hi:[1,0]
    v_pk_fma_f32 v[66:67], v[46:47], v[50:51], v[66:67]
    v_cvt_pk_bf16_f32 v53, v66, v67
    v_lshlrev_b32 v44, 16, v206
    v_and_b32 v45, 0xffff0000, v206
    v_lshlrev_b32 v46, 16, v207
    v_and_b32 v47, 0xffff0000, v207
    v_lshlrev_b32 v48, 16, v130
    v_and_b32 v49, 0xffff0000, v130
    v_lshlrev_b32 v50, 16, v131
    v_and_b32 v51, 0xffff0000, v131
    v_pk_add_f32 v[72:73], v[72:73], v[44:45]
    v_pk_add_f32 v[44:45], v[44:45], v[200:201] op_sel_hi:[1,0] neg_lo:[0,1] neg_hi:[0,1]
    v_pk_mul_f32 v[48:49], v[48:49], v[40:41] op_sel_hi:[1,0]
    v_pk_fma_f32 v[72:73], v[44:45], v[48:49], v[72:73]
    v_cvt_pk_bf16_f32 v54, v72, v73
    v_pk_add_f32 v[74:75], v[74:75], v[46:47]
    v_pk_add_f32 v[46:47], v[46:47], v[200:201] op_sel_hi:[1,0] neg_lo:[0,1] neg_hi:[0,1]
    v_pk_mul_f32 v[50:51], v[50:51], v[40:41] op_sel_hi:[1,0]
    v_pk_fma_f32 v[74:75], v[46:47], v[50:51], v[74:75]
    v_cvt_pk_bf16_f32 v55, v74, v75
    s_nop 1
    v_permlane16_swap_b32 v52, v54
    v_permlane16_swap_b32 v53, v55
    buffer_store_dwordx4 v[52:55], v193, s[48:51], 0 offen
    v_lshlrev_b32 v44, 16, v208
    v_and_b32 v45, 0xffff0000, v208
    v_lshlrev_b32 v46, 16, v209
    v_and_b32 v47, 0xffff0000, v209
    v_lshlrev_b32 v48, 16, v132
    v_and_b32 v49, 0xffff0000, v132
    v_lshlrev_b32 v50, 16, v133
    v_and_b32 v51, 0xffff0000, v133
    v_pk_add_f32 v[68:69], v[68:69], v[44:45]
    v_pk_add_f32 v[44:45], v[44:45], v[202:203] op_sel_hi:[1,0] neg_lo:[0,1] neg_hi:[0,1]
    v_pk_mul_f32 v[48:49], v[48:49], v[42:43] op_sel_hi:[1,0]
    v_pk_fma_f32 v[68:69], v[44:45], v[48:49], v[68:69]
    v_cvt_pk_bf16_f32 v56, v68, v69
    v_pk_add_f32 v[70:71], v[70:71], v[46:47]
    v_pk_add_f32 v[46:47], v[46:47], v[202:203] op_sel_hi:[1,0] neg_lo:[0,1] neg_hi:[0,1]
    v_pk_mul_f32 v[50:51], v[50:51], v[42:43] op_sel_hi:[1,0]
    v_pk_fma_f32 v[70:71], v[46:47], v[50:51], v[70:71]
    v_cvt_pk_bf16_f32 v57, v70, v71
    v_lshlrev_b32 v44, 16, v210
    v_and_b32 v45, 0xffff0000, v210
    v_lshlrev_b32 v46, 16, v211
    v_and_b32 v47, 0xffff0000, v211
    v_lshlrev_b32 v48, 16, v134
    v_and_b32 v49, 0xffff0000, v134
    v_lshlrev_b32 v50, 16, v135
    v_and_b32 v51, 0xffff0000, v135
    v_pk_add_f32 v[76:77], v[76:77], v[44:45]
    v_pk_add_f32 v[44:45], v[44:45], v[202:203] op_sel_hi:[1,0] neg_lo:[0,1] neg_hi:[0,1]
    v_pk_mul_f32 v[48:49], v[48:49], v[42:43] op_sel_hi:[1,0]
    v_pk_fma_f32 v[76:77], v[44:45], v[48:49], v[76:77]
    v_cvt_pk_bf16_f32 v58, v76, v77
    v_pk_add_f32 v[78:79], v[78:79], v[46:47]
    v_pk_add_f32 v[46:47], v[46:47], v[202:203] op_sel_hi:[1,0] neg_lo:[0,1] neg_hi:[0,1]
    v_pk_mul_f32 v[50:51], v[50:51], v[42:43] op_sel_hi:[1,0]
    v_pk_fma_f32 v[78:79], v[46:47], v[50:51], v[78:79]
    v_cvt_pk_bf16_f32 v59, v78, v79
    s_nop 1
    v_permlane16_swap_b32 v56, v58
    v_permlane16_swap_b32 v57, v59
    buffer_store_dwordx4 v[56:59], v193, s[48:51], s61 offen
    s_endpgm
L_loader:
    s_sub_u32 s60, s3, 4
    s_lshr_b32 s61, s60, 1
    s_and_b32 s62, s60, 1
    s_mov_b32 s40, s4
    s_mov_b32 s41, s5
    s_mov_b32 s42, 2097152
    s_mov_b32 s43, 0x00020000
    v_lshlrev_b32 v9, 4, v2
    s_lshl_b32 s64, s2, 13
    s_lshl_b32 s65, s60, 11
    s_add_u32 s64, s64, s65
    s_mov_b32 s76, s64
    s_lshl_b32 s64, s2, 1
    s_add_u32 s64, s64, s61
    s_lshl_b32 s64, s64, 12
    s_add_u32 s44, s12, s64
    s_addc_u32 s45, s13, 0
    s_mov_b32 s46, 4096
    s_mov_b32 s47, 0x00020000
    s_mov_b32 s48, s18
    s_mov_b32 s49, s19
    s_mov_b32 s50, 1835008
    s_mov_b32 s51, 0x00020000
    s_add_u32 s52, s26, 1048576
    s_addc_u32 s53, s27, 0
    s_mov_b32 s54, 2097152
    s_mov_b32 s55, 0x00020000
    s_cmp_ge_u32 s60, 2
    s_cbranch_scc1 L_wload
    v_lshrrev_b32 v12, 3, v2
    v_and_b32 v13, 7, v2
    v_xor_b32 v13, v13, v12
    v_lshlrev_b32 v13, 4, v13
    v_lshl_add_u32 v48, v12, 10, v13
    s_lshl_b32 s66, s35, 7
    s_lshl_b32 s67, s60, 6
    s_add_u32 s66, s66, s67
    s_lshl_b32 s66, s66, 10
    s_lshl_b32 s67, s60, 13
    s_add_u32 s68, s17, 0
    s_and_b32 s68, s68, 7
    s_lshl_b32 s68, s68, 7
    s_add_u32 s68, s68, s66
    s_add_u32 m0, s67, 40960
    s_nop 0
    buffer_load_dwordx4 v48, s[40:43], s68 offen lds
    s_add_u32 m0, m0, 1024
    s_add_u32 s68, s68, 8192
    buffer_load_dwordx4 v48, s[40:43], s68 offen lds
    s_add_u32 m0, m0, 1024
    s_add_u32 s68, s68, 8192
    buffer_load_dwordx4 v48, s[40:43], s68 offen lds
    s_add_u32 m0, m0, 1024
    s_add_u32 s68, s68, 8192
    buffer_load_dwordx4 v48, s[40:43], s68 offen lds
    s_add_u32 m0, m0, 1024
    s_add_u32 s68, s68, 8192
    buffer_load_dwordx4 v48, s[40:43], s68 offen lds
    s_add_u32 m0, m0, 1024
    s_add_u32 s68, s68, 8192
    buffer_load_dwordx4 v48, s[40:43], s68 offen lds
    s_add_u32 m0, m0, 1024
    s_add_u32 s68, s68, 8192
    buffer_load_dwordx4 v48, s[40:43], s68 offen lds
    s_add_u32 m0, m0, 1024
    s_add_u32 s68, s68, 8192
    buffer_load_dwordx4 v48, s[40:43], s68 offen lds
    s_barrier
    buffer_load_dwordx4 v[16:19], v9, s[40:43], s76 offen
    buffer_load_dwordx4 v[20:23], v9, s[40:43], s76 offen offset:1024
    s_add_u32 s68, s17, 1
    s_and_b32 s68, s68, 7
    s_lshl_b32 s68, s68, 7
    s_add_u32 s68, s68, s66
    s_add_u32 m0, s67, 71680
    s_nop 0
    buffer_load_dwordx4 v48, s[40:43], s68 offen lds
    s_add_u32 m0, m0, 1024
    s_add_u32 s68, s68, 8192
    buffer_load_dwordx4 v48, s[40:43], s68 offen lds
    s_add_u32 m0, m0, 1024
    s_add_u32 s68, s68, 8192
    buffer_load_dwordx4 v48, s[40:43], s68 offen lds
    s_add_u32 m0, m0, 1024
    s_add_u32 s68, s68, 8192
    buffer_load_dwordx4 v48, s[40:43], s68 offen lds
    s_add_u32 m0, m0, 1024
    s_add_u32 s68, s68, 8192
    buffer_load_dwordx4 v48, s[40:43], s68 offen lds
    s_add_u32 m0, m0, 1024
    s_add_u32 s68, s68, 8192
    buffer_load_dwordx4 v48, s[40:43], s68 offen lds
    s_add_u32 m0, m0, 1024
    s_add_u32 s68, s68, 8192
    buffer_load_dwordx4 v48, s[40:43], s68 offen lds
    s_add_u32 m0, m0, 1024
    s_add_u32 s68, s68, 8192
    buffer_load_dwordx4 v48, s[40:43], s68 offen lds
    s_add_u32 s68, s17, 2
    s_and_b32 s68, s68, 7
    s_lshl_b32 s68, s68, 7
    s_add_u32 s68, s68, s66
    s_add_u32 m0, s67, 102400
    s_nop 0
    buffer_load_dwordx4 v48, s[40:43], s68 offen lds
    s_add_u32 m0, m0, 1024
    s_add_u32 s68, s68, 8192
    buffer_load_dwordx4 v48, s[40:43], s68 offen lds
    s_add_u32 m0, m0, 1024
    s_add_u32 s68, s68, 8192
    buffer_load_dwordx4 v48, s[40:43], s68 offen lds
    s_add_u32 m0, m0, 1024
    s_add_u32 s68, s68, 8192
    buffer_load_dwordx4 v48, s[40:43], s68 offen lds
    s_add_u32 m0, m0, 1024
    s_add_u32 s68, s68, 8192
    buffer_load_dwordx4 v48, s[40:43], s68 offen lds
    s_add_u32 m0, m0, 1024
    s_add_u32 s68, s68, 8192
    buffer_load_dwordx4 v48, s[40:43], s68 offen lds
    s_add_u32 m0, m0, 1024
    s_add_u32 s68, s68, 8192
    buffer_load_dwordx4 v48, s[40:43], s68 offen lds
    s_add_u32 m0, m0, 1024
    s_add_u32 s68, s68, 8192
    buffer_load_dwordx4 v48, s[40:43], s68 offen lds
    s_waitcnt vmcnt(18)
    s_barrier
    s_waitcnt vmcnt(16)
    s_add_u32 s68, s17, 3
    s_and_b32 s68, s68, 7
    s_lshl_b32 s68, s68, 7
    s_add_u32 s68, s68, s66
    s_add_u32 m0, s67, 133120
    s_nop 0
    buffer_load_dwordx4 v48, s[40:43], s68 offen lds
    v_lshlrev_b32 v64, 16, v16
    v_and_b32 v65, 0xffff0000, v16
    v_lshlrev_b32 v66, 16, v17
    v_and_b32 v67, 0xffff0000, v17
    v_lshlrev_b32 v68, 16, v18
    v_and_b32 v69, 0xffff0000, v18
    v_lshlrev_b32 v70, 16, v19
    v_and_b32 v71, 0xffff0000, v19
    v_lshlrev_b32 v72, 16, v20
    v_and_b32 v73, 0xffff0000, v20
    v_lshlrev_b32 v74, 16, v21
    v_and_b32 v75, 0xffff0000, v21
    v_lshlrev_b32 v76, 16, v22
    v_and_b32 v77, 0xffff0000, v22
    v_lshlrev_b32 v78, 16, v23
    s_add_u32 m0, m0, 1024
    s_add_u32 s68, s68, 8192
    buffer_load_dwordx4 v48, s[40:43], s68 offen lds
    v_and_b32 v79, 0xffff0000, v23
    v_pk_add_f32 v[80:81], v[64:65], v[66:67]
    v_pk_add_f32 v[84:85], v[68:69], v[70:71]
    v_pk_add_f32 v[82:83], v[72:73], v[74:75]
    v_pk_add_f32 v[86:87], v[76:77], v[78:79]
    v_pk_add_f32 v[80:81], v[80:81], v[84:85]
    v_pk_add_f32 v[82:83], v[82:83], v[86:87]
    v_add_f32 v80, v80, v81
    v_add_f32 v82, v82, v83
    s_nop 1
    v_add_f32_dpp v80, v80, v80 quad_perm:[1,0,3,2] row_mask:0xf bank_mask:0xf
    v_add_f32_dpp v82, v82, v82 quad_perm:[1,0,3,2] row_mask:0xf bank_mask:0xf
    s_nop 1
    v_add_f32_dpp v80, v80, v80 quad_perm:[2,3,0,1] row_mask:0xf bank_mask:0xf
    v_add_f32_dpp v82, v82, v82 quad_perm:[2,3,0,1] row_mask:0xf bank_mask:0xf
    s_add_u32 m0, m0, 1024
    s_add_u32 s68, s68, 8192
    buffer_load_dwordx4 v48, s[40:43], s68 offen lds
    s_nop 1
    v_add_f32_dpp v80, v80, v80 row_half_mirror row_mask:0xf bank_mask:0xf
    v_add_f32_dpp v82, v82, v82 row_half_mirror row_mask:0xf bank_mask:0xf
    s_nop 1
    v_add_f32_dpp v80, v80, v80 row_mirror row_mask:0xf bank_mask:0xf
    v_add_f32_dpp v82, v82, v82 row_mirror row_mask:0xf bank_mask:0xf
    v_mov_b32 v84, v80
    v_mov_b32 v85, v82
    s_nop 1
    v_permlane16_swap_b32 v84, v80
    v_permlane16_swap_b32 v85, v82
    s_nop 1
    v_add_f32 v80, v80, v84
    v_add_f32 v82, v82, v85
    v_mov_b32 v84, v80
    s_add_u32 m0, m0, 1024
    s_add_u32 s68, s68, 8192
    buffer_load_dwordx4 v48, s[40:43], s68 offen lds
    v_mov_b32 v85, v82
    s_nop 1
    v_permlane32_swap_b32 v84, v80
    v_permlane32_swap_b32 v85, v82
    s_nop 1
    v_add_f32 v80, v80, v84
    v_add_f32 v82, v82, v85
    v_mul_f32 v80, 0x3b000000, v80
    v_mul_f32 v82, 0x3b000000, v82
    v_pk_add_f32 v[64:65], v[64:65], v[80:81] op_sel_hi:[1,0] neg_lo:[0,1] neg_hi:[0,1]
    v_pk_add_f32 v[66:67], v[66:67], v[80:81] op_sel_hi:[1,0] neg_lo:[0,1] neg_hi:[0,1]
    v_pk_add_f32 v[68:69], v[68:69], v[80:81] op_sel_hi:[1,0] neg_lo:[0,1] neg_hi:[0,1]
    v_pk_add_f32 v[70:71], v[70:71], v[80:81] op_sel_hi:[1,0] neg_lo:[0,1] neg_hi:[0,1]
    v_pk_add_f32 v[72:73], v[72:73], v[82:83] op_sel_hi:[1,0] neg_lo:[0,1] neg_hi:[0,1]
    v_pk_add_f32 v[74:75], v[74:75], v[82:83] op_sel_hi:[1,0] neg_lo:[0,1] neg_hi:[0,1]
    s_add_u32 m0, m0, 1024
    s_add_u32 s68, s68, 8192
    buffer_load_dwordx4 v48, s[40:43], s68 offen lds
    v_pk_add_f32 v[76:77], v[76:77], v[82:83] op_sel_hi:[1,0] neg_lo:[0,1] neg_hi:[0,1]
    v_pk_add_f32 v[78:79], v[78:79], v[82:83] op_sel_hi:[1,0] neg_lo:[0,1] neg_hi:[0,1]
    v_pk_mul_f32 v[88:89], v[64:65], v[64:65]
    v_pk_fma_f32 v[88:89], v[66:67], v[66:67], v[88:89]
    v_pk_fma_f32 v[88:89], v[68:69], v[68:69], v[88:89]
    v_pk_fma_f32 v[88:89], v[70:71], v[70:71], v[88:89]
    v_pk_mul_f32 v[90:91], v[72:73], v[72:73]
    v_pk_fma_f32 v[90:91], v[74:75], v[74:75], v[90:91]
    v_pk_fma_f32 v[90:91], v[76:77], v[76:77], v[90:91]
    v_pk_fma_f32 v[90:91], v[78:79], v[78:79], v[90:91]
    v_add_f32 v88, v88, v89
    v_add_f32 v90, v90, v91
    s_nop 1
    v_add_f32_dpp v88, v88, v88 quad_perm:[1,0,3,2] row_mask:0xf bank_mask:0xf
    v_add_f32_dpp v90, v90, v90 quad_perm:[1,0,3,2] row_mask:0xf bank_mask:0xf
    s_add_u32 m0, m0, 1024
    s_add_u32 s68, s68, 8192
    buffer_load_dwordx4 v48, s[40:43], s68 offen lds
    s_nop 1
    v_add_f32_dpp v88, v88, v88 quad_perm:[2,3,0,1] row_mask:0xf bank_mask:0xf
    v_add_f32_dpp v90, v90, v90 quad_perm:[2,3,0,1] row_mask:0xf bank_mask:0xf
    s_nop 1
    v_add_f32_dpp v88, v88, v88 row_half_mirror row_mask:0xf bank_mask:0xf
    v_add_f32_dpp v90, v90, v90 row_half_mirror row_mask:0xf bank_mask:0xf
    s_nop 1
    v_add_f32_dpp v88, v88, v88 row_mirror row_mask:0xf bank_mask:0xf
    v_add_f32_dpp v90, v90, v90 row_mirror row_mask:0xf bank_mask:0xf
    v_mov_b32 v84, v88
    v_mov_b32 v85, v90
    s_nop 1
    v_permlane16_swap_b32 v84, v88
    v_permlane16_swap_b32 v85, v90
    s_nop 1
    s_add_u32 m0, m0, 1024
    s_add_u32 s68, s68, 8192
    buffer_load_dwordx4 v48, s[40:43], s68 offen lds
    v_add_f32 v88, v88, v84
    v_add_f32 v90, v90, v85
    v_mov_b32 v84, v88
    v_mov_b32 v85, v90
    s_nop 1
    v_permlane32_swap_b32 v84, v88
    v_permlane32_swap_b32 v85, v90
    s_nop 1
    v_add_f32 v88, v88, v84
    v_add_f32 v90, v90, v85
    s_waitcnt lgkmcnt(0)
    s_mul_i32 s32, s32, 0x9E3779B1
    s_add_u32 s32, s32, 0x7F4A7C15
    v_mul_f32 v88, 0x3b000000, v88
    v_cvt_pk_bf16_f32 v88, v88, v88
    s_add_u32 m0, m0, 1024
    s_add_u32 s68, s68, 8192
    buffer_load_dwordx4 v48, s[40:43], s68 offen lds
    v_and_b32 v88, 0xffff0000, v88
    v_add_f32 v88, 0x3727c5ac, v88
    v_cvt_pk_bf16_f32 v88, v88, v88
    v_and_b32 v88, 0xffff0000, v88
    v_sqrt_f32 v88, v88
    s_nop 0
    v_cvt_pk_bf16_f32 v92, v80, v88
    v_mov_b32 v93, s32
    v_mul_f32 v90, 0x3b000000, v90
    v_cvt_pk_bf16_f32 v90, v90, v90
    v_and_b32 v90, 0xffff0000, v90
    v_add_f32 v90, 0x3727c5ac, v90
    v_cvt_pk_bf16_f32 v90, v90, v90
    v_and_b32 v90, 0xffff0000, v90
    v_sqrt_f32 v90, v90
    s_nop 0
    v_cvt_pk_bf16_f32 v94, v82, v90
    v_mov_b32 v95, s32
    s_lshl_b32 s64, s2, 6
    s_lshl_b32 s65, s60, 4
    s_add_u32 s64, s64, s65
    v_mov_b32 v10, 0
    s_mov_b64 exec, 1
    buffer_store_dwordx2 v[92:93], v10, s[28:31], s64 offen sc1
    buffer_store_dwordx2 v[94:95], v10, s[28:31], s64 offen offset:8 sc1
    s_mov_b64 exec, -1
    s_waitcnt vmcnt(18)
    s_barrier
    s_add_u32 s68, s17, 4
    s_and_b32 s68, s68, 7
    s_lshl_b32 s68, s68, 7
    s_add_u32 s68, s68, s66
    s_add_u32 m0, s67, 40960
    s_nop 0
    buffer_load_dwordx4 v48, s[40:43], s68 offen lds
    s_add_u32 m0, m0, 1024
    s_add_u32 s68, s68, 8192
    buffer_load_dwordx4 v48, s[40:43], s68 offen lds
    s_add_u32 m0, m0, 1024
    s_add_u32 s68, s68, 8192
    buffer_load_dwordx4 v48, s[40:43], s68 offen lds
    s_add_u32 m0, m0, 1024
    s_add_u32 s68, s68, 8192
    buffer_load_dwordx4 v48, s[40:43], s68 offen lds
    s_add_u32 m0, m0, 1024
    s_add_u32 s68, s68, 8192
    buffer_load_dwordx4 v48, s[40:43], s68 offen lds
    s_add_u32 m0, m0, 1024
    s_add_u32 s68, s68, 8192
    buffer_load_dwordx4 v48, s[40:43], s68 offen lds
    s_add_u32 m0, m0, 1024
    s_add_u32 s68, s68, 8192
    buffer_load_dwordx4 v48, s[40:43], s68 offen lds
    s_add_u32 m0, m0, 1024
    s_add_u32 s68, s68, 8192
    buffer_load_dwordx4 v48, s[40:43], s68 offen lds
    s_lshl_b32 s64, s62, 7
    v_add_u32 v5, s64, v2
    v_lshlrev_b32 v6, 4, v5
    v_add_u32 v7, -8, v6
    v_add_u32 v8, 1016, v6
    buffer_load_dwordx2 v[24:25], v7, s[44:47], 0 offen
    buffer_load_dwordx4 v[26:29], v6, s[44:47], 0 offen
    buffer_load_dwordx2 v[32:33], v8, s[44:47], 0 offen
    buffer_load_dwordx4 v[34:37], v6, s[44:47], 0 offen offset:1024
    s_waitcnt vmcnt(22)
    s_barrier
    s_add_u32 s68, s17, 5
    s_and_b32 s68, s68, 7
    s_lshl_b32 s68, s68, 7
    s_add_u32 s68, s68, s66
    s_add_u32 m0, s67, 71680
    s_nop 0
    buffer_load_dwordx4 v48, s[40:43], s68 offen lds
    s_add_u32 m0, m0, 1024
    s_add_u32 s68, s68, 8192
    buffer_load_dwordx4 v48, s[40:43], s68 offen lds
    s_add_u32 m0, m0, 1024
    s_add_u32 s68, s68, 8192
    buffer_load_dwordx4 v48, s[40:43], s68 offen lds
    s_add_u32 m0, m0, 1024
    s_add_u32 s68, s68, 8192
    buffer_load_dwordx4 v48, s[40:43], s68 offen lds
    s_add_u32 m0, m0, 1024
    s_add_u32 s68, s68, 8192
    buffer_load_dwordx4 v48, s[40:43], s68 offen lds
    s_add_u32 m0, m0, 1024
    s_add_u32 s68, s68, 8192
    buffer_load_dwordx4 v48, s[40:43], s68 offen lds
    s_add_u32 m0, m0, 1024
    s_add_u32 s68, s68, 8192
    buffer_load_dwordx4 v48, s[40:43], s68 offen lds
    s_add_u32 m0, m0, 1024
    s_add_u32 s68, s68, 8192
    buffer_load_dwordx4 v48, s[40:43], s68 offen lds
    s_cmp_eq_u32 s60, 0
    s_cbranch_scc0 L_nopf_9
    s_lshl_b32 s64, s2, 7
    s_add_u32 s64, s64, 65536
    v_mov_b32 v12, s32
    v_mov_b32 v13, 0
    s_mov_b64 exec, 1
    buffer_store_dword v12, v13, s[28:31], s64 offen sc1
    s_mov_b64 exec, -1
L_nopf_9:
    s_waitcnt vmcnt(22)
    s_barrier
    s_add_u32 s68, s17, 6
    s_and_b32 s68, s68, 7
    s_lshl_b32 s68, s68, 7
    s_add_u32 s68, s68, s66
    s_add_u32 m0, s67, 102400
    s_nop 0
    buffer_load_dwordx4 v48, s[40:43], s68 offen lds
    s_add_u32 m0, m0, 1024
    s_add_u32 s68, s68, 8192
    buffer_load_dwordx4 v48, s[40:43], s68 offen lds
    s_add_u32 m0, m0, 1024
    s_add_u32 s68, s68, 8192
    buffer_load_dwordx4 v48, s[40:43], s68 offen lds
    s_add_u32 m0, m0, 1024
    s_add_u32 s68, s68, 8192
    buffer_load_dwordx4 v48, s[40:43], s68 offen lds
    s_add_u32 m0, m0, 1024
    s_add_u32 s68, s68, 8192
    buffer_load_dwordx4 v48, s[40:43], s68 offen lds
    s_add_u32 m0, m0, 1024
    s_add_u32 s68, s68, 8192
    buffer_load_dwordx4 v48, s[40:43], s68 offen lds
    s_add_u32 m0, m0, 1024
    s_add_u32 s68, s68, 8192
    buffer_load_dwordx4 v48, s[40:43], s68 offen lds
    s_add_u32 m0, m0, 1024
    s_add_u32 s68, s68, 8192
    buffer_load_dwordx4 v48, s[40:43], s68 offen lds
    s_waitcnt vmcnt(20)
    s_barrier
    s_add_u32 s68, s17, 7
    s_and_b32 s68, s68, 7
    s_lshl_b32 s68, s68, 7
    s_add_u32 s68, s68, s66
    s_add_u32 m0, s67, 133120
    s_nop 0
    buffer_load_dwordx4 v48, s[40:43], s68 offen lds
    s_add_u32 m0, m0, 1024
    s_add_u32 s68, s68, 8192
    buffer_load_dwordx4 v48, s[40:43], s68 offen lds
    s_add_u32 m0, m0, 1024
    s_add_u32 s68, s68, 8192
    buffer_load_dwordx4 v48, s[40:43], s68 offen lds
    s_add_u32 m0, m0, 1024
    s_add_u32 s68, s68, 8192
    buffer_load_dwordx4 v48, s[40:43], s68 offen lds
    s_add_u32 m0, m0, 1024
    s_add_u32 s68, s68, 8192
    buffer_load_dwordx4 v48, s[40:43], s68 offen lds
    s_add_u32 m0, m0, 1024
    s_add_u32 s68, s68, 8192
    buffer_load_dwordx4 v48, s[40:43], s68 offen lds
    s_add_u32 m0, m0, 1024
    s_add_u32 s68, s68, 8192
    buffer_load_dwordx4 v48, s[40:43], s68 offen lds
    s_add_u32 m0, m0, 1024
    s_add_u32 s68, s68, 8192
    buffer_load_dwordx4 v48, s[40:43], s68 offen lds
    s_waitcnt vmcnt(16)
    s_barrier
    s_lshl_b32 s64, s35, 7
    s_lshl_b32 s73, s60, 6
    s_add_u32 s64, s64, s73
    s_lshl_b32 s73, s64, 3
    v_lshlrev_b32 v11, 3, v2
    buffer_load_dwordx2 v[14:15], v11, s[28:31], s73 offen sc1
    s_waitcnt lgkmcnt(0)
    s_waitcnt vmcnt(9)
    s_barrier
    v_lshlrev_b32 v12, 10, v2
    s_lshr_b32 s65, s2, 5
    s_lshl_b32 s65, s65, 7
    s_add_u32 s65, s65, 65536
    buffer_load_dword v13, v12, s[28:31], s65 offen sc1
    s_waitcnt lgkmcnt(0)
    s_waitcnt vmcnt(0)
    v_cmp_ne_u32 vcc, s32, v13
    s_nop 1
    s_mov_b32 vcc_hi, 0
    s_cmp_eq_u64 vcc, 0
    s_cselect_b32 s78, 1, 0
    v_cmp_ne_u32 vcc, s32, v15
    s_nop 1
    s_cbranch_vccz L_stok_10
    v_lshlrev_b32 v11, 3, v2
    s_mov_b32 s39, 200000
L_poll_11:
    buffer_load_dwordx2 v[14:15], v11, s[28:31], s73 offen sc1
    s_waitcnt vmcnt(0)
    v_cmp_ne_u32 vcc, s32, v15
    s_nop 1
    s_mov_b64 s[74:75], vcc
    s_cmp_eq_u64 s[74:75], 0
    s_cbranch_scc1 L_pdone_12
    s_sub_u32 s39, s39, 1
    s_cbranch_scc1 L_pdone_12
    s_sleep 1
    s_branch L_poll_11
L_pdone_12:
L_stok_10:
    s_barrier
    s_cmp_eq_u32 s78, 1
    s_cbranch_scc0 L_nokv_13
    s_lshl_b32 s64, s2, 1
    s_add_u32 s64, s64, s60
    s_lshl_b32 s65, s64, 12
    s_lshl_b32 s64, s60, 12
    s_add_u32 m0, s64, 0
    s_nop 0
    buffer_load_dwordx4 v9, s[52:55], s65 offen sc1 lds
    s_add_u32 m0, m0, 1024
    s_add_u32 s65, s65, 1024
    buffer_load_dwordx4 v9, s[52:55], s65 offen sc1 lds
    s_add_u32 m0, m0, 1024
    s_add_u32 s65, s65, 1024
    buffer_load_dwordx4 v9, s[52:55], s65 offen sc1 lds
    s_add_u32 m0, m0, 1024
    s_add_u32 s65, s65, 1024
    buffer_load_dwordx4 v9, s[52:55], s65 offen sc1 lds
L_nokv_13:
    v_and_b32 v15, 0xffff0000, v14
    v_lshlrev_b32 v14, 16, v14
    s_lshl_b32 s64, s60, 9
    v_lshl_add_u32 v11, v2, 3, s64
    ds_write_b64 v11, v[14:15] offset:41472
    v_mov_b32 v16, 0
    v_mov_b32 v17, 0
    v_mov_b32 v11, 0
    ds_write_b64 v11, v[16:17] offset:42496
    ds_write_b64 v11, v[16:17] offset:42504
    s_waitcnt lgkmcnt(0)
    s_barrier
    s_barrier
    v_lshrrev_b32 v10, 2, v5
    v_lshlrev_b32 v10, 8, v10
    v_and_b32 v6, 3, v5
    v_lshl_add_u32 v10, v6, 4, v10
    s_lshl_b32 s64, s61, 14
    s_add_u32 s64, s64, 8192
    v_add_u32 v10, s64, v10
    v_alignbit_b32 v64, v26, v25, 16
    v_alignbit_b32 v68, v25, v24, 16
    v_mov_b32 v72, v25
    v_alignbit_b32 v65, v27, v26, 16
    v_alignbit_b32 v69, v26, v25, 16
    v_mov_b32 v73, v26
    v_alignbit_b32 v66, v28, v27, 16
    v_alignbit_b32 v70, v27, v26, 16
    v_mov_b32 v74, v27
    v_alignbit_b32 v67, v29, v28, 16
    v_alignbit_b32 v71, v28, v27, 16
    v_mov_b32 v75, v28
    ds_write_b128 v10, v[26:29] offset:0
    ds_write_b128 v10, v[64:67] offset:64
    ds_write_b128 v10, v[72:75] offset:128
    ds_write_b128 v10, v[68:71] offset:192
    v_alignbit_b32 v76, v34, v33, 16
    v_alignbit_b32 v80, v33, v32, 16
    v_mov_b32 v84, v33
    v_alignbit_b32 v77, v35, v34, 16
    v_alignbit_b32 v81, v34, v33, 16
    v_mov_b32 v85, v34
    v_alignbit_b32 v78, v36, v35, 16
    v_alignbit_b32 v82, v35, v34, 16
    v_mov_b32 v86, v35
    v_alignbit_b32 v79, v37, v36, 16
    v_alignbit_b32 v83, v36, v35, 16
    v_mov_b32 v87, v36
    ds_write_b128 v10, v[34:37] offset:4096
    ds_write_b128 v10, v[76:79] offset:4160
    ds_write_b128 v10, v[84:87] offset:4224
    ds_write_b128 v10, v[80:83] offset:4288
    s_waitcnt lgkmcnt(0)
    s_cmp_eq_u32 s78, 1
    s_cbranch_scc1 L_kvdone_14
    v_lshlrev_b32 v12, 10, v2
    s_lshr_b32 s65, s2, 5
    s_lshl_b32 s65, s65, 7
    s_add_u32 s65, s65, 65536
    s_mov_b32 s39, 200000
L_poll_15:
    buffer_load_dword v13, v12, s[28:31], s65 offen sc1
    s_waitcnt vmcnt(0)
    v_cmp_ne_u32 vcc, s32, v13
    s_nop 1
    s_mov_b32 vcc_hi, 0
    s_mov_b64 s[74:75], vcc
    s_cmp_eq_u64 s[74:75], 0
    s_cbranch_scc1 L_pdone_16
    s_sub_u32 s39, s39, 1
    s_cbranch_scc1 L_pdone_16
    s_sleep 1
    s_branch L_poll_15
L_pdone_16:
    s_lshl_b32 s64, s2, 1
    s_add_u32 s64, s64, s60
    s_lshl_b32 s65, s64, 12
    s_lshl_b32 s64, s60, 12
    s_add_u32 m0, s64, 0
    s_nop 0
    buffer_load_dwordx4 v9, s[52:55], s65 offen sc1 lds
    s_add_u32 m0, m0, 1024
    s_add_u32 s65, s65, 1024
    buffer_load_dwordx4 v9, s[52:55], s65 offen sc1 lds
    s_add_u32 m0, m0, 1024
    s_add_u32 s65, s65, 1024
    buffer_load_dwordx4 v9, s[52:55], s65 offen sc1 lds
    s_add_u32 m0, m0, 1024
    s_add_u32 s65, s65, 1024
    buffer_load_dwordx4 v9, s[52:55], s65 offen sc1 lds
L_kvdone_14:
    s_waitcnt vmcnt(0)
    s_lshl_b32 s64, s35, 4
    s_add_u32 s64, s64, s36
    s_lshl_b32 s64, s64, 7
    s_add_u32 s64, s64, 131072
    v_mov_b32 v14, s32
    v_mov_b32 v13, 0
    s_barrier
    s_cmp_eq_u32 s60, 0
    s_cbranch_scc0 L_nohf_17
    s_mov_b64 exec, 1
    buffer_store_dword v14, v13, s[28:31], s64 offen sc1
    s_mov_b64 exec, -1
L_nohf_17:
    s_add_u32 s56, s26, 5242880
    s_addc_u32 s57, s27, 0
    s_mov_b32 s58, 7340032
    s_mov_b32 s59, 0x00020000
    v_and_b32 v5, 15, v2
    v_lshlrev_b32 v11, 7, v5
    s_lshr_b32 s64, s37, 1
    s_lshl_b32 s64, s64, 11
    s_add_u32 s70, s64, 131072
    v_lshlrev_b32 v12, 4, v2
    s_lshl_b32 s68, s37, 2
    s_lshl_b32 s64, s60, 1
    s_add_u32 s68, s68, s64
    s_mul_i32 s66, s68, 57344
    s_mov_b32 s71, s16
    s_lshl_b32 s68, s16, 11
    s_add_u32 s68, s68, s66
    s_lshl_b32 s69, s60, 12
    s_mov_b32 s39, 200000
    buffer_load_dword v14, v11, s[28:31], s70 offen sc1
L_hpoll_18:
    buffer_load_dword v15, v11, s[28:31], s70 offen sc1
    s_waitcnt vmcnt(1)
    v_cmp_ne_u32 vcc, s32, v14
    s_nop 1
    s_cbranch_vccz L_hdone_19
    buffer_load_dword v14, v11, s[28:31], s70 offen sc1
    s_waitcnt vmcnt(1)
    v_cmp_ne_u32 vcc, s32, v15
    s_nop 1
    s_cbranch_vccz L_hdone_19
    s_sub_u32 s39, s39, 1
    s_cbranch_scc0 L_hpoll_18
L_hdone_19:
    s_add_u32 m0, s69, 114688
    s_add_u32 s64, s68, 1024
    buffer_load_dwordx4 v12, s[56:59], s68 offen lds
    s_add_u32 m0, m0, 1024
    s_add_u32 s65, s68, 57344
    buffer_load_dwordx4 v12, s[56:59], s64 offen lds
    s_add_u32 m0, m0, 1024
    s_add_u32 s64, s64, 57344
    buffer_load_dwordx4 v12, s[56:59], s65 offen lds
    s_add_u32 m0, m0, 1024
    s_add_u32 s68, s68, 2048
    buffer_load_dwordx4 v12, s[56:59], s64 offen lds
    s_add_u32 s71, s71, 1
    s_cmp_eq_u32 s71, 28
    s_cselect_b32 s68, s66, s68
    s_cselect_b32 s71, 0, s71
    s_add_u32 m0, s69, 122880
    s_add_u32 s64, s68, 1024
    buffer_load_dwordx4 v12, s[56:59], s68 offen lds
    s_add_u32 m0, m0, 1024
    s_add_u32 s65, s68, 57344
    buffer_load_dwordx4 v12, s[56:59], s64 offen lds
    s_add_u32 m0, m0, 1024
    s_add_u32 s64, s64, 57344
    buffer_load_dwordx4 v12, s[56:59], s65 offen lds
    s_add_u32 m0, m0, 1024
    s_add_u32 s68, s68, 2048
    buffer_load_dwordx4 v12, s[56:59], s64 offen lds
    s_add_u32 s71, s71, 1
    s_cmp_eq_u32 s71, 28
    s_cselect_b32 s68, s66, s68
    s_cselect_b32 s71, 0, s71
    s_add_u32 m0, s69, 131072
    s_add_u32 s64, s68, 1024
    buffer_load_dwordx4 v12, s[56:59], s68 offen lds
    s_add_u32 m0, m0, 1024
    s_add_u32 s65, s68, 57344
    buffer_load_dwordx4 v12, s[56:59], s64 offen lds
    s_add_u32 m0, m0, 1024
    s_add_u32 s64, s64, 57344
    buffer_load_dwordx4 v12, s[56:59], s65 offen lds
    s_add_u32 m0, m0, 1024
    s_add_u32 s68, s68, 2048
    buffer_load_dwordx4 v12, s[56:59], s64 offen lds
    s_add_u32 s71, s71, 1
    s_cmp_eq_u32 s71, 28
    s_cselect_b32 s68, s66, s68
    s_cselect_b32 s71, 0, s71
    s_add_u32 m0, s69, 139264
    s_add_u32 s64, s68, 1024
    buffer_load_dwordx4 v12, s[56:59], s68 offen lds
    s_add_u32 m0, m0, 1024
    s_add_u32 s65, s68, 57344
    buffer_load_dwordx4 v12, s[56:59], s64 offen lds
    s_add_u32 m0, m0, 1024
    s_add_u32 s64, s64, 57344
    buffer_load_dwordx4 v12, s[56:59], s65 offen lds
    s_add_u32 m0, m0, 1024
    s_add_u32 s68, s68, 2048
    buffer_load_dwordx4 v12, s[56:59], s64 offen lds
    s_add_u32 s71, s71, 1
    s_cmp_eq_u32 s71, 28
    s_cselect_b32 s68, s66, s68
    s_cselect_b32 s71, 0, s71
    s_add_u32 m0, s69, 147456
    s_add_u32 s64, s68, 1024
    buffer_load_dwordx4 v12, s[56:59], s68 offen lds
    s_add_u32 m0, m0, 1024
    s_add_u32 s65, s68, 57344
    buffer_load_dwordx4 v12, s[56:59], s64 offen lds
    s_add_u32 m0, m0, 1024
    s_add_u32 s64, s64, 57344
    buffer_load_dwordx4 v12, s[56:59], s65 offen lds
    s_add_u32 m0, m0, 1024
    s_add_u32 s68, s68, 2048
    buffer_load_dwordx4 v12, s[56:59], s64 offen lds
    s_add_u32 s71, s71, 1
    s_cmp_eq_u32 s71, 28
    s_cselect_b32 s68, s66, s68
    s_cselect_b32 s71, 0, s71
    s_add_u32 m0, s69, 155648
    s_add_u32 s64, s68, 1024
    buffer_load_dwordx4 v12, s[56:59], s68 offen lds
    s_add_u32 m0, m0, 1024
    s_add_u32 s65, s68, 57344
    buffer_load_dwordx4 v12, s[56:59], s64 offen lds
    s_add_u32 m0, m0, 1024
    s_add_u32 s64, s64, 57344
    buffer_load_dwordx4 v12, s[56:59], s65 offen lds
    s_add_u32 m0, m0, 1024
    s_add_u32 s68, s68, 2048
    buffer_load_dwordx4 v12, s[56:59], s64 offen lds
    s_add_u32 s71, s71, 1
    s_cmp_eq_u32 s71, 28
    s_cselect_b32 s68, s66, s68
    s_cselect_b32 s71, 0, s71
    s_waitcnt vmcnt(16)
    s_barrier
    s_add_u32 m0, s69, 0
    s_add_u32 s64, s68, 1024
    buffer_load_dwordx4 v12, s[56:59], s68 offen lds
    s_add_u32 m0, m0, 1024
    s_add_u32 s65, s68, 57344
    buffer_load_dwordx4 v12, s[56:59], s64 offen lds
    s_add_u32 m0, m0, 1024
    s_add_u32 s64, s64, 57344
    buffer_load_dwordx4 v12, s[56:59], s65 offen lds
    s_add_u32 m0, m0, 1024
    s_add_u32 s68, s68, 2048
    buffer_load_dwordx4 v12, s[56:59], s64 offen lds
    s_add_u32 s71, s71, 1
    s_cmp_eq_u32 s71, 28
    s_cselect_b32 s68, s66, s68
    s_cselect_b32 s71, 0, s71
    s_add_u32 m0, s69, 8192
    s_add_u32 s64, s68, 1024
    buffer_load_dwordx4 v12, s[56:59], s68 offen lds
    s_add_u32 m0, m0, 1024
    s_add_u32 s65, s68, 57344
    buffer_load_dwordx4 v12, s[56:59], s64 offen lds
    s_add_u32 m0, m0, 1024
    s_add_u32 s64, s64, 57344
    buffer_load_dwordx4 v12, s[56:59], s65 offen lds
    s_add_u32 m0, m0, 1024
    s_add_u32 s68, s68, 2048
    buffer_load_dwordx4 v12, s[56:59], s64 offen lds
    s_add_u32 s71, s71, 1
    s_cmp_eq_u32 s71, 28
    s_cselect_b32 s68, s66, s68
    s_cselect_b32 s71, 0, s71
    s_waitcnt vmcnt(20)
    s_barrier
    s_add_u32 m0, s69, 114688
    s_add_u32 s64, s68, 1024
    buffer_load_dwordx4 v12, s[56:59], s68 offen lds
    s_add_u32 m0, m0, 1024
    s_add_u32 s65, s68, 57344
    buffer_load_dwordx4 v12, s[56:59], s64 offen lds
    s_add_u32 m0, m0, 1024
    s_add_u32 s64, s64, 57344
    buffer_load_dwordx4 v12, s[56:59], s65 offen lds
    s_add_u32 m0, m0, 1024
    s_add_u32 s68, s68, 2048
    buffer_load_dwordx4 v12, s[56:59], s64 offen lds
    s_add_u32 s71, s71, 1
    s_cmp_eq_u32 s71, 28
    s_cselect_b32 s68, s66, s68
    s_cselect_b32 s71, 0, s71
    s_waitcnt vmcnt(20)
    s_barrier
    s_add_u32 m0, s69, 122880
    s_add_u32 s64, s68, 1024
    buffer_load_dwordx4 v12, s[56:59], s68 offen lds
    s_add_u32 m0, m0, 1024
    s_add_u32 s65, s68, 57344
    buffer_load_dwordx4 v12, s[56:59], s64 offen lds
    s_add_u32 m0, m0, 1024
    s_add_u32 s64, s64, 57344
    buffer_load_dwordx4 v12, s[56:59], s65 offen lds
    s_add_u32 m0, m0, 1024
    s_add_u32 s68, s68, 2048
    buffer_load_dwordx4 v12, s[56:59], s64 offen lds
    s_add_u32 s71, s71, 1
    s_cmp_eq_u32 s71, 28
    s_cselect_b32 s68, s66, s68
    s_cselect_b32 s71, 0, s71
    s_waitcnt vmcnt(20)
    s_barrier
    s_add_u32 m0, s69, 131072
    s_add_u32 s64, s68, 1024
    buffer_load_dwordx4 v12, s[56:59], s68 offen lds
    s_add_u32 m0, m0, 1024
    s_add_u32 s65, s68, 57344
    buffer_load_dwordx4 v12, s[56:59], s64 offen lds
    s_add_u32 m0, m0, 1024
    s_add_u32 s64, s64, 57344
    buffer_load_dwordx4 v12, s[56:59], s65 offen lds
    s_add_u32 m0, m0, 1024
    s_add_u32 s68, s68, 2048
    buffer_load_dwordx4 v12, s[56:59], s64 offen lds
    s_add_u32 s71, s71, 1
    s_cmp_eq_u32 s71, 28
    s_cselect_b32 s68, s66, s68
    s_cselect_b32 s71, 0, s71
    s_waitcnt vmcnt(20)
    s_barrier
    s_add_u32 m0, s69, 139264
    s_add_u32 s64, s68, 1024
    buffer_load_dwordx4 v12, s[56:59], s68 offen lds
    s_add_u32 m0, m0, 1024
    s_add_u32 s65, s68, 57344
    buffer_load_dwordx4 v12, s[56:59], s64 offen lds
    s_add_u32 m0, m0, 1024
    s_add_u32 s64, s64, 57344
    buffer_load_dwordx4 v12, s[56:59], s65 offen lds
    s_add_u32 m0, m0, 1024
    s_add_u32 s68, s68, 2048
    buffer_load_dwordx4 v12, s[56:59], s64 offen lds
    s_add_u32 s71, s71, 1
    s_cmp_eq_u32 s71, 28
    s_cselect_b32 s68, s66, s68
    s_cselect_b32 s71, 0, s71
    s_waitcnt vmcnt(20)
    s_barrier
    s_add_u32 m0, s69, 147456
    s_add_u32 s64, s68, 1024
    buffer_load_dwordx4 v12, s[56:59], s68 offen lds
    s_add_u32 m0, m0, 1024
    s_add_u32 s65, s68, 57344
    buffer_load_dwordx4 v12, s[56:59], s64 offen lds
    s_add_u32 m0, m0, 1024
    s_add_u32 s64, s64, 57344
    buffer_load_dwordx4 v12, s[56:59], s65 offen lds
    s_add_u32 m0, m0, 1024
    s_add_u32 s68, s68, 2048
    buffer_load_dwordx4 v12, s[56:59], s64 offen lds
    s_add_u32 s71, s71, 1
    s_cmp_eq_u32 s71, 28
    s_cselect_b32 s68, s66, s68
    s_cselect_b32 s71, 0, s71
    s_cmp_eq_u32 s60, 0
    s_cbranch_scc0 L_noyf_20
    s_lshl_b32 s64, s2, 7
    s_add_u32 s64, s64, 262144
    v_mov_b32 v13, s32
    v_mov_b32 v14, 0
    s_mov_b64 exec, 1
    buffer_store_dword v13, v14, s[28:31], s64 offen sc1
    s_mov_b64 exec, -1
L_noyf_20:
    s_waitcnt vmcnt(20)
    s_barrier
    s_add_u32 m0, s69, 155648
    s_add_u32 s64, s68, 1024
    buffer_load_dwordx4 v12, s[56:59], s68 offen lds
    s_add_u32 m0, m0, 1024
    s_add_u32 s65, s68, 57344
    buffer_load_dwordx4 v12, s[56:59], s64 offen lds
    s_add_u32 m0, m0, 1024
    s_add_u32 s64, s64, 57344
    buffer_load_dwordx4 v12, s[56:59], s65 offen lds
    s_add_u32 m0, m0, 1024
    s_add_u32 s68, s68, 2048
    buffer_load_dwordx4 v12, s[56:59], s64 offen lds
    s_add_u32 s71, s71, 1
    s_cmp_eq_u32 s71, 28
    s_cselect_b32 s68, s66, s68
    s_cselect_b32 s71, 0, s71
    s_waitcnt vmcnt(20)
    s_barrier
    s_add_u32 m0, s69, 0
    s_add_u32 s64, s68, 1024
    buffer_load_dwordx4 v12, s[56:59], s68 offen lds
    s_add_u32 m0, m0, 1024
    s_add_u32 s65, s68, 57344
    buffer_load_dwordx4 v12, s[56:59], s64 offen lds
    s_add_u32 m0, m0, 1024
    s_add_u32 s64, s64, 57344
    buffer_load_dwordx4 v12, s[56:59], s65 offen lds
    s_add_u32 m0, m0, 1024
    s_add_u32 s68, s68, 2048
    buffer_load_dwordx4 v12, s[56:59], s64 offen lds
    s_add_u32 s71, s71, 1
    s_cmp_eq_u32 s71, 28
    s_cselect_b32 s68, s66, s68
    s_cselect_b32 s71, 0, s71
    s_waitcnt vmcnt(20)
    s_barrier
    s_add_u32 m0, s69, 8192
    s_add_u32 s64, s68, 1024
    buffer_load_dwordx4 v12, s[56:59], s68 offen lds
    s_add_u32 m0, m0, 1024
    s_add_u32 s65, s68, 57344
    buffer_load_dwordx4 v12, s[56:59], s64 offen lds
    s_add_u32 m0, m0, 1024
    s_add_u32 s64, s64, 57344
    buffer_load_dwordx4 v12, s[56:59], s65 offen lds
    s_add_u32 m0, m0, 1024
    s_add_u32 s68, s68, 2048
    buffer_load_dwordx4 v12, s[56:59], s64 offen lds
    s_add_u32 s71, s71, 1
    s_cmp_eq_u32 s71, 28
    s_cselect_b32 s68, s66, s68
    s_cselect_b32 s71, 0, s71
    s_waitcnt vmcnt(20)
    s_barrier
    s_add_u32 m0, s69, 114688
    s_add_u32 s64, s68, 1024
    buffer_load_dwordx4 v12, s[56:59], s68 offen lds
    s_add_u32 m0, m0, 1024
    s_add_u32 s65, s68, 57344
    buffer_load_dwordx4 v12, s[56:59], s64 offen lds
    s_add_u32 m0, m0, 1024
    s_add_u32 s64, s64, 57344
    buffer_load_dwordx4 v12, s[56:59], s65 offen lds
    s_add_u32 m0, m0, 1024
    s_add_u32 s68, s68, 2048
    buffer_load_dwordx4 v12, s[56:59], s64 offen lds
    s_add_u32 s71, s71, 1
    s_cmp_eq_u32 s71, 28
    s_cselect_b32 s68, s66, s68
    s_cselect_b32 s71, 0, s71
    s_waitcnt vmcnt(20)
    s_barrier
    s_add_u32 m0, s69, 122880
    s_add_u32 s64, s68, 1024
    buffer_load_dwordx4 v12, s[56:59], s68 offen lds
    s_add_u32 m0, m0, 1024
    s_add_u32 s65, s68, 57344
    buffer_load_dwordx4 v12, s[56:59], s64 offen lds
    s_add_u32 m0, m0, 1024
    s_add_u32 s64, s64, 57344
    buffer_load_dwordx4 v12, s[56:59], s65 offen lds
    s_add_u32 m0, m0, 1024
    s_add_u32 s68, s68, 2048
    buffer_load_dwordx4 v12, s[56:59], s64 offen lds
    s_add_u32 s71, s71, 1
    s_cmp_eq_u32 s71, 28
    s_cselect_b32 s68, s66, s68
    s_cselect_b32 s71, 0, s71
    s_waitcnt vmcnt(20)
    s_barrier
    s_add_u32 m0, s69, 131072
    s_add_u32 s64, s68, 1024
    buffer_load_dwordx4 v12, s[56:59], s68 offen lds
    s_add_u32 m0, m0, 1024
    s_add_u32 s65, s68, 57344
    buffer_load_dwordx4 v12, s[56:59], s64 offen lds
    s_add_u32 m0, m0, 1024
    s_add_u32 s64, s64, 57344
    buffer_load_dwordx4 v12, s[56:59], s65 offen lds
    s_add_u32 m0, m0, 1024
    s_add_u32 s68, s68, 2048
    buffer_load_dwordx4 v12, s[56:59], s64 offen lds
    s_add_u32 s71, s71, 1
    s_cmp_eq_u32 s71, 28
    s_cselect_b32 s68, s66, s68
    s_cselect_b32 s71, 0, s71
    s_waitcnt vmcnt(20)
    s_barrier
    s_add_u32 m0, s69, 139264
    s_add_u32 s64, s68, 1024
    buffer_load_dwordx4 v12, s[56:59], s68 offen lds
    s_add_u32 m0, m0, 1024
    s_add_u32 s65, s68, 57344
    buffer_load_dwordx4 v12, s[56:59], s64 offen lds
    s_add_u32 m0, m0, 1024
    s_add_u32 s64, s64, 57344
    buffer_load_dwordx4 v12, s[56:59], s65 offen lds
    s_add_u32 m0, m0, 1024
    s_add_u32 s68, s68, 2048
    buffer_load_dwordx4 v12, s[56:59], s64 offen lds
    s_add_u32 s71, s71, 1
    s_cmp_eq_u32 s71, 28
    s_cselect_b32 s68, s66, s68
    s_cselect_b32 s71, 0, s71
    s_waitcnt vmcnt(20)
    s_barrier
    s_add_u32 m0, s69, 147456
    s_add_u32 s64, s68, 1024
    buffer_load_dwordx4 v12, s[56:59], s68 offen lds
    s_add_u32 m0, m0, 1024
    s_add_u32 s65, s68, 57344
    buffer_load_dwordx4 v12, s[56:59], s64 offen lds
    s_add_u32 m0, m0, 1024
    s_add_u32 s64, s64, 57344
    buffer_load_dwordx4 v12, s[56:59], s65 offen lds
    s_add_u32 m0, m0, 1024
    s_add_u32 s68, s68, 2048
    buffer_load_dwordx4 v12, s[56:59], s64 offen lds
    s_add_u32 s71, s71, 1
    s_cmp_eq_u32 s71, 28
    s_cselect_b32 s68, s66, s68
    s_cselect_b32 s71, 0, s71
    s_waitcnt vmcnt(20)
    s_barrier
    s_add_u32 m0, s69, 155648
    s_add_u32 s64, s68, 1024
    buffer_load_dwordx4 v12, s[56:59], s68 offen lds
    s_add_u32 m0, m0, 1024
    s_add_u32 s65, s68, 57344
    buffer_load_dwordx4 v12, s[56:59], s64 offen lds
    s_add_u32 m0, m0, 1024
    s_add_u32 s64, s64, 57344
    buffer_load_dwordx4 v12, s[56:59], s65 offen lds
    s_add_u32 m0, m0, 1024
    s_add_u32 s68, s68, 2048
    buffer_load_dwordx4 v12, s[56:59], s64 offen lds
    s_add_u32 s71, s71, 1
    s_cmp_eq_u32 s71, 28
    s_cselect_b32 s68, s66, s68
    s_cselect_b32 s71, 0, s71
    s_waitcnt vmcnt(20)
    s_barrier
    s_add_u32 m0, s69, 0
    s_add_u32 s64, s68, 1024
    buffer_load_dwordx4 v12, s[56:59], s68 offen lds
    s_add_u32 m0, m0, 1024
    s_add_u32 s65, s68, 57344
    buffer_load_dwordx4 v12, s[56:59], s64 offen lds
    s_add_u32 m0, m0, 1024
    s_add_u32 s64, s64, 57344
    buffer_load_dwordx4 v12, s[56:59], s65 offen lds
    s_add_u32 m0, m0, 1024
    s_add_u32 s68, s68, 2048
    buffer_load_dwordx4 v12, s[56:59], s64 offen lds
    s_add_u32 s71, s71, 1
    s_cmp_eq_u32 s71, 28
    s_cselect_b32 s68, s66, s68
    s_cselect_b32 s71, 0, s71
    s_waitcnt vmcnt(20)
    s_barrier
    s_add_u32 m0, s69, 8192
    s_add_u32 s64, s68, 1024
    buffer_load_dwordx4 v12, s[56:59], s68 offen lds
    s_add_u32 m0, m0, 1024
    s_add_u32 s65, s68, 57344
    buffer_load_dwordx4 v12, s[56:59], s64 offen lds
    s_add_u32 m0, m0, 1024
    s_add_u32 s64, s64, 57344
    buffer_load_dwordx4 v12, s[56:59], s65 offen lds
    s_add_u32 m0, m0, 1024
    s_add_u32 s68, s68, 2048
    buffer_load_dwordx4 v12, s[56:59], s64 offen lds
    s_add_u32 s71, s71, 1
    s_cmp_eq_u32 s71, 28
    s_cselect_b32 s68, s66, s68
    s_cselect_b32 s71, 0, s71
    s_waitcnt vmcnt(20)
    s_barrier
    s_add_u32 m0, s69, 114688
    s_add_u32 s64, s68, 1024
    buffer_load_dwordx4 v12, s[56:59], s68 offen lds
    s_add_u32 m0, m0, 1024
    s_add_u32 s65, s68, 57344
    buffer_load_dwordx4 v12, s[56:59], s64 offen lds
    s_add_u32 m0, m0, 1024
    s_add_u32 s64, s64, 57344
    buffer_load_dwordx4 v12, s[56:59], s65 offen lds
    s_add_u32 m0, m0, 1024
    s_add_u32 s68, s68, 2048
    buffer_load_dwordx4 v12, s[56:59], s64 offen lds
    s_add_u32 s71, s71, 1
    s_cmp_eq_u32 s71, 28
    s_cselect_b32 s68, s66, s68
    s_cselect_b32 s71, 0, s71
    s_waitcnt vmcnt(20)
    s_barrier
    s_add_u32 m0, s69, 122880
    s_add_u32 s64, s68, 1024
    buffer_load_dwordx4 v12, s[56:59], s68 offen lds
    s_add_u32 m0, m0, 1024
    s_add_u32 s65, s68, 57344
    buffer_load_dwordx4 v12, s[56:59], s64 offen lds
    s_add_u32 m0, m0, 1024
    s_add_u32 s64, s64, 57344
    buffer_load_dwordx4 v12, s[56:59], s65 offen lds
    s_add_u32 m0, m0, 1024
    s_add_u32 s68, s68, 2048
    buffer_load_dwordx4 v12, s[56:59], s64 offen lds
    s_add_u32 s71, s71, 1
    s_cmp_eq_u32 s71, 28
    s_cselect_b32 s68, s66, s68
    s_cselect_b32 s71, 0, s71
    s_waitcnt vmcnt(20)
    s_barrier
    s_add_u32 m0, s69, 131072
    s_add_u32 s64, s68, 1024
    buffer_load_dwordx4 v12, s[56:59], s68 offen lds
    s_add_u32 m0, m0, 1024
    s_add_u32 s65, s68, 57344
    buffer_load_dwordx4 v12, s[56:59], s64 offen lds
    s_add_u32 m0, m0, 1024
    s_add_u32 s64, s64, 57344
    buffer_load_dwordx4 v12, s[56:59], s65 offen lds
    s_add_u32 m0, m0, 1024
    s_add_u32 s68, s68, 2048
    buffer_load_dwordx4 v12, s[56:59], s64 offen lds
    s_add_u32 s71, s71, 1
    s_cmp_eq_u32 s71, 28
    s_cselect_b32 s68, s66, s68
    s_cselect_b32 s71, 0, s71
    s_waitcnt vmcnt(20)
    s_barrier
    s_add_u32 m0, s69, 139264
    s_add_u32 s64, s68, 1024
    buffer_load_dwordx4 v12, s[56:59], s68 offen lds
    s_add_u32 m0, m0, 1024
    s_add_u32 s65, s68, 57344
    buffer_load_dwordx4 v12, s[56:59], s64 offen lds
    s_add_u32 m0, m0, 1024
    s_add_u32 s64, s64, 57344
    buffer_load_dwordx4 v12, s[56:59], s65 offen lds
    s_add_u32 m0, m0, 1024
    s_add_u32 s68, s68, 2048
    buffer_load_dwordx4 v12, s[56:59], s64 offen lds
    s_add_u32 s71, s71, 1
    s_cmp_eq_u32 s71, 28
    s_cselect_b32 s68, s66, s68
    s_cselect_b32 s71, 0, s71
    s_waitcnt vmcnt(20)
    s_barrier
    s_waitcnt vmcnt(16)
    s_barrier
    s_waitcnt vmcnt(12)
    s_barrier
    s_waitcnt vmcnt(8)
    s_barrier
    s_waitcnt vmcnt(4)
    s_barrier
    s_waitcnt vmcnt(0)
    s_barrier
    s_barrier
    s_barrier
    s_cmp_eq_u32 s2, 0
    s_cbranch_scc0 L_noe_21
    s_cmp_eq_u32 s60, 0
    s_cbranch_scc0 L_noe_21
    v_lshlrev_b32 v11, 7, v2
    s_mov_b32 s64, 131072
    s_mov_b32 s65, 139264
    s_mov_b32 s66, 147456
    s_mov_b32 s67, 155648
    s_mov_b32 s39, 200000
L_poll_22:
    buffer_load_dword v14, v11, s[28:31], s64 offen sc1
    buffer_load_dword v15, v11, s[28:31], s65 offen sc1
    buffer_load_dword v16, v11, s[28:31], s66 offen sc1
    buffer_load_dword v17, v11, s[28:31], s67 offen sc1
    s_waitcnt vmcnt(0)
    v_cmp_ne_u32 vcc, s32, v14
    s_nop 1
    s_mov_b64 s[74:75], vcc
    v_cmp_ne_u32 vcc, s32, v15
    s_nop 1
    s_or_b64 s[74:75], s[74:75], vcc
    v_cmp_ne_u32 vcc, s32, v16
    s_nop 1
    s_or_b64 s[74:75], s[74:75], vcc
    v_cmp_ne_u32 vcc, s32, v17
    s_nop 1
    s_or_b64 s[74:75], s[74:75], vcc
    s_cmp_eq_u64 s[74:75], 0
    s_cbranch_scc1 L_pdone_23
    s_sub_u32 s39, s39, 1
    s_cbranch_scc1 L_pdone_23
    s_sleep 1
    s_branch L_poll_22
L_pdone_23:
    s_mov_b32 s64, 32768
    v_mov_b32 v14, s32
    v_mov_b32 v13, 0
    s_mov_b64 exec, 1
    buffer_store_dword v14, v13, s[28:31], s64 offen sc1
    s_mov_b64 exec, -1
L_noe_21:
    s_endpgm
L_wload:
    s_sub_u32 s67, s60, 2
    v_add_u32 v12, 0, v2
    v_mul_u32_u24 v13, 4682, v12
    v_lshrrev_b32 v13, 16, v13
    v_mul_u32_u24 v14, 14, v13
    v_sub_u32 v14, v12, v14
    v_and_b32 v15, 0x13, v13
    v_and_b32 v12, 4, v13
    v_lshl_or_b32 v15, v12, 1, v15
    v_and_b32 v12, 8, v13
    v_lshrrev_b32 v12, 1, v12
    v_or_b32 v15, v15, v12
    v_mul_u32_u24 v15, 3584, v15
    v_lshl_add_u32 v48, v14, 4, v15
    v_add_u32 v12, 64, v2
    v_mul_u32_u24 v13, 4682, v12
    v_lshrrev_b32 v13, 16, v13
    v_mul_u32_u24 v14, 14, v13
    v_sub_u32 v14, v12, v14
    v_and_b32 v15, 0x13, v13
    v_and_b32 v12, 4, v13
    v_lshl_or_b32 v15, v12, 1, v15
    v_and_b32 v12, 8, v13
    v_lshrrev_b32 v12, 1, v12
    v_or_b32 v15, v15, v12
    v_mul_u32_u24 v15, 3584, v15
    v_lshl_add_u32 v49, v14, 4, v15
    v_add_u32 v12, 128, v2
    v_mul_u32_u24 v13, 4682, v12
    v_lshrrev_b32 v13, 16, v13
    v_mul_u32_u24 v14, 14, v13
    v_sub_u32 v14, v12, v14
    v_and_b32 v15, 0x13, v13
    v_and_b32 v12, 4, v13
    v_lshl_or_b32 v15, v12, 1, v15
    v_and_b32 v12, 8, v13
    v_lshrrev_b32 v12, 1, v12
    v_or_b32 v15, v15, v12
    v_mul_u32_u24 v15, 3584, v15
    v_lshl_add_u32 v50, v14, 4, v15
    v_add_u32 v12, 192, v2
    v_mul_u32_u24 v13, 4682, v12
    v_lshrrev_b32 v13, 16, v13
    v_mul_u32_u24 v14, 14, v13
    v_sub_u32 v14, v12, v14
    v_and_b32 v15, 0x13, v13
    v_and_b32 v12, 4, v13
    v_lshl_or_b32 v15, v12, 1, v15
    v_and_b32 v12, 8, v13
    v_lshrrev_b32 v12, 1, v12
    v_or_b32 v15, v15, v12
    v_mul_u32_u24 v15, 3584, v15
    v_lshl_add_u32 v51, v14, 4, v15
    v_add_u32 v12, 256, v2
    v_mul_u32_u24 v13, 4682, v12
    v_lshrrev_b32 v13, 16, v13
    v_mul_u32_u24 v14, 14, v13
    v_sub_u32 v14, v12, v14
    v_and_b32 v15, 0x13, v13
    v_and_b32 v12, 4, v13
    v_lshl_or_b32 v15, v12, 1, v15
    v_and_b32 v12, 8, v13
    v_lshrrev_b32 v12, 1, v12
    v_or_b32 v15, v15, v12
    v_mul_u32_u24 v15, 3584, v15
    v_lshl_add_u32 v52, v14, 4, v15
    v_add_u32 v12, 320, v2
    v_mul_u32_u24 v13, 4682, v12
    v_lshrrev_b32 v13, 16, v13
    v_mul_u32_u24 v14, 14, v13
    v_sub_u32 v14, v12, v14
    v_and_b32 v15, 0x13, v13
    v_and_b32 v12, 4, v13
    v_lshl_or_b32 v15, v12, 1, v15
    v_and_b32 v12, 8, v13
    v_lshrrev_b32 v12, 1, v12
    v_or_b32 v15, v15, v12
    v_mul_u32_u24 v15, 3584, v15
    v_lshl_add_u32 v53, v14, 4, v15
    v_add_u32 v12, 384, v2
    v_mul_u32_u24 v13, 4682, v12
    v_lshrrev_b32 v13, 16, v13
    v_mul_u32_u24 v14, 14, v13
    v_sub_u32 v14, v12, v14
    v_and_b32 v15, 0x13, v13
    v_and_b32 v12, 4, v13
    v_lshl_or_b32 v15, v12, 1, v15
    v_and_b32 v12, 8, v13
    v_lshrrev_b32 v12, 1, v12
    v_or_b32 v15, v15, v12
    v_mul_u32_u24 v15, 3584, v15
    v_lshl_add_u32 v54, v14, 4, v15
    s_mul_i32 s66, s67, 114688
    s_mul_i32 s68, s36, 224
    s_add_u32 s66, s66, s68
    s_mul_i32 s67, s67, 7168
    s_lshl_b32 s64, s2, 1
    s_cmp_eq_u32 s60, 2
    s_cbranch_scc0 L_notc1_25
    v_min_u32 v12, 55, v2
    v_mul_u32_u24 v13, 2341, v12
    v_lshrrev_b32 v13, 16, v13
    v_mul_u32_u24 v14, 28, v13
    v_sub_u32 v14, v12, v14
    v_add_u32 v13, s64, v13
    v_mul_u32_u24 v13, 3584, v13
    v_lshl_add_u32 v13, v14, 7, v13
    buffer_load_dword v177, v13, s[48:51], 0 offen
L_notc1_25:
    s_add_u32 s68, s17, 0
    s_and_b32 s68, s68, 7
    s_mul_i32 s68, s68, 229376
    s_add_u32 s68, s68, s66
    s_add_u32 m0, s67, 57344
    s_nop 0
    buffer_load_dwordx4 v48, s[48:51], s68 offen lds
    s_add_u32 m0, m0, 1024
    s_nop 0
    buffer_load_dwordx4 v49, s[48:51], s68 offen lds
    s_add_u32 m0, m0, 1024
    s_nop 0
    buffer_load_dwordx4 v50, s[48:51], s68 offen lds
    s_add_u32 m0, m0, 1024
    s_nop 0
    buffer_load_dwordx4 v51, s[48:51], s68 offen lds
    s_add_u32 m0, m0, 1024
    s_nop 0
    buffer_load_dwordx4 v52, s[48:51], s68 offen lds
    s_add_u32 m0, m0, 1024
    s_nop 0
    buffer_load_dwordx4 v53, s[48:51], s68 offen lds
    s_add_u32 m0, m0, 1024
    s_nop 0
    buffer_load_dwordx4 v54, s[48:51], s68 offen lds
    s_barrier
    buffer_load_dwordx4 v[16:19], v9, s[40:43], s76 offen
    buffer_load_dwordx4 v[20:23], v9, s[40:43], s76 offen offset:1024
    s_add_u32 s68, s17, 1
    s_and_b32 s68, s68, 7
    s_mul_i32 s68, s68, 229376
    s_add_u32 s68, s68, s66
    s_add_u32 m0, s67, 88064
    s_nop 0
    buffer_load_dwordx4 v48, s[48:51], s68 offen lds
    s_add_u32 m0, m0, 1024
    s_nop 0
    buffer_load_dwordx4 v49, s[48:51], s68 offen lds
    s_add_u32 m0, m0, 1024
    s_nop 0
    buffer_load_dwordx4 v50, s[48:51], s68 offen lds
    s_add_u32 m0, m0, 1024
    s_nop 0
    buffer_load_dwordx4 v51, s[48:51], s68 offen lds
    s_add_u32 m0, m0, 1024
    s_nop 0
    buffer_load_dwordx4 v52, s[48:51], s68 offen lds
    s_add_u32 m0, m0, 1024
    s_nop 0
    buffer_load_dwordx4 v53, s[48:51], s68 offen lds
    s_add_u32 m0, m0, 1024
    s_nop 0
    buffer_load_dwordx4 v54, s[48:51], s68 offen lds
    s_add_u32 s68, s17, 2
    s_and_b32 s68, s68, 7
    s_mul_i32 s68, s68, 229376
    s_add_u32 s68, s68, s66
    s_add_u32 m0, s67, 118784
    s_nop 0
    buffer_load_dwordx4 v48, s[48:51], s68 offen lds
    s_add_u32 m0, m0, 1024
    s_nop 0
    buffer_load_dwordx4 v49, s[48:51], s68 offen lds
    s_add_u32 m0, m0, 1024
    s_nop 0
    buffer_load_dwordx4 v50, s[48:51], s68 offen lds
    s_add_u32 m0, m0, 1024
    s_nop 0
    buffer_load_dwordx4 v51, s[48:51], s68 offen lds
    s_add_u32 m0, m0, 1024
    s_nop 0
    buffer_load_dwordx4 v52, s[48:51], s68 offen lds
    s_add_u32 m0, m0, 1024
    s_nop 0
    buffer_load_dwordx4 v53, s[48:51], s68 offen lds
    s_add_u32 m0, m0, 1024
    s_nop 0
    buffer_load_dwordx4 v54, s[48:51], s68 offen lds
    s_waitcnt vmcnt(16)
    s_barrier
    s_waitcnt vmcnt(14)
    s_add_u32 s68, s17, 3
    s_and_b32 s68, s68, 7
    s_mul_i32 s68, s68, 229376
    s_add_u32 s68, s68, s66
    s_add_u32 m0, s67, 149504
    s_nop 0
    buffer_load_dwordx4 v48, s[48:51], s68 offen lds
    v_lshlrev_b32 v64, 16, v16
    v_and_b32 v65, 0xffff0000, v16
    v_lshlrev_b32 v66, 16, v17
    v_and_b32 v67, 0xffff0000, v17
    v_lshlrev_b32 v68, 16, v18
    v_and_b32 v69, 0xffff0000, v18
    v_lshlrev_b32 v70, 16, v19
    v_and_b32 v71, 0xffff0000, v19
    v_lshlrev_b32 v72, 16, v20
    v_and_b32 v73, 0xffff0000, v20
    v_lshlrev_b32 v74, 16, v21
    v_and_b32 v75, 0xffff0000, v21
    v_lshlrev_b32 v76, 16, v22
    v_and_b32 v77, 0xffff0000, v22
    v_lshlrev_b32 v78, 16, v23
    s_add_u32 m0, m0, 1024
    s_nop 0
    buffer_load_dwordx4 v49, s[48:51], s68 offen lds
    v_and_b32 v79, 0xffff0000, v23
    v_pk_add_f32 v[80:81], v[64:65], v[66:67]
    v_pk_add_f32 v[84:85], v[68:69], v[70:71]
    v_pk_add_f32 v[82:83], v[72:73], v[74:75]
    v_pk_add_f32 v[86:87], v[76:77], v[78:79]
    v_pk_add_f32 v[80:81], v[80:81], v[84:85]
    v_pk_add_f32 v[82:83], v[82:83], v[86:87]
    v_add_f32 v80, v80, v81
    v_add_f32 v82, v82, v83
    s_nop 1
    v_add_f32_dpp v80, v80, v80 quad_perm:[1,0,3,2] row_mask:0xf bank_mask:0xf
    v_add_f32_dpp v82, v82, v82 quad_perm:[1,0,3,2] row_mask:0xf bank_mask:0xf
    s_nop 1
    v_add_f32_dpp v80, v80, v80 quad_perm:[2,3,0,1] row_mask:0xf bank_mask:0xf
    v_add_f32_dpp v82, v82, v82 quad_perm:[2,3,0,1] row_mask:0xf bank_mask:0xf
    s_add_u32 m0, m0, 1024
    s_nop 0
    buffer_load_dwordx4 v50, s[48:51], s68 offen lds
    s_nop 1
    v_add_f32_dpp v80, v80, v80 row_half_mirror row_mask:0xf bank_mask:0xf
    v_add_f32_dpp v82, v82, v82 row_half_mirror row_mask:0xf bank_mask:0xf
    s_nop 1
    v_add_f32_dpp v80, v80, v80 row_mirror row_mask:0xf bank_mask:0xf
    v_add_f32_dpp v82, v82, v82 row_mirror row_mask:0xf bank_mask:0xf
    v_mov_b32 v84, v80
    v_mov_b32 v85, v82
    s_nop 1
    v_permlane16_swap_b32 v84, v80
    v_permlane16_swap_b32 v85, v82
    s_nop 1
    v_add_f32 v80, v80, v84
    v_add_f32 v82, v82, v85
    v_mov_b32 v84, v80
    s_add_u32 m0, m0, 1024
    s_nop 0
    buffer_load_dwordx4 v51, s[48:51], s68 offen lds
    v_mov_b32 v85, v82
    s_nop 1
    v_permlane32_swap_b32 v84, v80
    v_permlane32_swap_b32 v85, v82
    s_nop 1
    v_add_f32 v80, v80, v84
    v_add_f32 v82, v82, v85
    v_mul_f32 v80, 0x3b000000, v80
    v_mul_f32 v82, 0x3b000000, v82
    v_pk_add_f32 v[64:65], v[64:65], v[80:81] op_sel_hi:[1,0] neg_lo:[0,1] neg_hi:[0,1]
    v_pk_add_f32 v[66:67], v[66:67], v[80:81] op_sel_hi:[1,0] neg_lo:[0,1] neg_hi:[0,1]
    v_pk_add_f32 v[68:69], v[68:69], v[80:81] op_sel_hi:[1,0] neg_lo:[0,1] neg_hi:[0,1]
    v_pk_add_f32 v[70:71], v[70:71], v[80:81] op_sel_hi:[1,0] neg_lo:[0,1] neg_hi:[0,1]
    v_pk_add_f32 v[72:73], v[72:73], v[82:83] op_sel_hi:[1,0] neg_lo:[0,1] neg_hi:[0,1]
    v_pk_add_f32 v[74:75], v[74:75], v[82:83] op_sel_hi:[1,0] neg_lo:[0,1] neg_hi:[0,1]
    s_add_u32 m0, m0, 1024
    s_nop 0
    buffer_load_dwordx4 v52, s[48:51], s68 offen lds
    v_pk_add_f32 v[76:77], v[76:77], v[82:83] op_sel_hi:[1,0] neg_lo:[0,1] neg_hi:[0,1]
    v_pk_add_f32 v[78:79], v[78:79], v[82:83] op_sel_hi:[1,0] neg_lo:[0,1] neg_hi:[0,1]
    v_pk_mul_f32 v[88:89], v[64:65], v[64:65]
    v_pk_fma_f32 v[88:89], v[66:67], v[66:67], v[88:89]
    v_pk_fma_f32 v[88:89], v[68:69], v[68:69], v[88:89]
    v_pk_fma_f32 v[88:89], v[70:71], v[70:71], v[88:89]
    v_pk_mul_f32 v[90:91], v[72:73], v[72:73]
    v_pk_fma_f32 v[90:91], v[74:75], v[74:75], v[90:91]
    v_pk_fma_f32 v[90:91], v[76:77], v[76:77], v[90:91]
    v_pk_fma_f32 v[90:91], v[78:79], v[78:79], v[90:91]
    v_add_f32 v88, v88, v89
    v_add_f32 v90, v90, v91
    s_nop 1
    v_add_f32_dpp v88, v88, v88 quad_perm:[1,0,3,2] row_mask:0xf bank_mask:0xf
    v_add_f32_dpp v90, v90, v90 quad_perm:[1,0,3,2] row_mask:0xf bank_mask:0xf
    s_add_u32 m0, m0, 1024
    s_nop 0
    buffer_load_dwordx4 v53, s[48:51], s68 offen lds
    s_nop 1
    v_add_f32_dpp v88, v88, v88 quad_perm:[2,3,0,1] row_mask:0xf bank_mask:0xf
    v_add_f32_dpp v90, v90, v90 quad_perm:[2,3,0,1] row_mask:0xf bank_mask:0xf
    s_nop 1
    v_add_f32_dpp v88, v88, v88 row_half_mirror row_mask:0xf bank_mask:0xf
    v_add_f32_dpp v90, v90, v90 row_half_mirror row_mask:0xf bank_mask:0xf
    s_nop 1
    v_add_f32_dpp v88, v88, v88 row_mirror row_mask:0xf bank_mask:0xf
    v_add_f32_dpp v90, v90, v90 row_mirror row_mask:0xf bank_mask:0xf
    v_mov_b32 v84, v88
    v_mov_b32 v85, v90
    s_nop 1
    v_permlane16_swap_b32 v84, v88
    v_permlane16_swap_b32 v85, v90
    s_nop 1
    s_add_u32 m0, m0, 1024
    s_nop 0
    buffer_load_dwordx4 v54, s[48:51], s68 offen lds
    v_add_f32 v88, v88, v84
    v_add_f32 v90, v90, v85
    v_mov_b32 v84, v88
    v_mov_b32 v85, v90
    s_nop 1
    v_permlane32_swap_b32 v84, v88
    v_permlane32_swap_b32 v85, v90
    s_nop 1
    v_add_f32 v88, v88, v84
    v_add_f32 v90, v90, v85
    s_waitcnt lgkmcnt(0)
    s_mul_i32 s32, s32, 0x9E3779B1
    s_add_u32 s32, s32, 0x7F4A7C15
    v_mul_f32 v88, 0x3b000000, v88
    v_cvt_pk_bf16_f32 v88, v88, v88
    v_and_b32 v88, 0xffff0000, v88
    v_add_f32 v88, 0x3727c5ac, v88
    v_cvt_pk_bf16_f32 v88, v88, v88
    v_and_b32 v88, 0xffff0000, v88
    v_sqrt_f32 v88, v88
    s_nop 0
    v_cvt_pk_bf16_f32 v92, v80, v88
    v_mov_b32 v93, s32
    v_mul_f32 v90, 0x3b000000, v90
    v_cvt_pk_bf16_f32 v90, v90, v90
    v_and_b32 v90, 0xffff0000, v90
    v_add_f32 v90, 0x3727c5ac, v90
    v_cvt_pk_bf16_f32 v90, v90, v90
    v_and_b32 v90, 0xffff0000, v90
    v_sqrt_f32 v90, v90
    s_nop 0
    v_cvt_pk_bf16_f32 v94, v82, v90
    v_mov_b32 v95, s32
    s_lshl_b32 s64, s2, 6
    s_lshl_b32 s65, s60, 4
    s_add_u32 s64, s64, s65
    v_mov_b32 v10, 0
    s_mov_b64 exec, 1
    buffer_store_dwordx2 v[92:93], v10, s[28:31], s64 offen sc1
    buffer_store_dwordx2 v[94:95], v10, s[28:31], s64 offen offset:8 sc1
    s_mov_b64 exec, -1
    s_waitcnt vmcnt(16)
    s_barrier
    s_add_u32 s68, s17, 4
    s_and_b32 s68, s68, 7
    s_mul_i32 s68, s68, 229376
    s_add_u32 s68, s68, s66
    s_add_u32 m0, s67, 57344
    s_nop 0
    buffer_load_dwordx4 v48, s[48:51], s68 offen lds
    s_add_u32 m0, m0, 1024
    s_nop 0
    buffer_load_dwordx4 v49, s[48:51], s68 offen lds
    s_add_u32 m0, m0, 1024
    s_nop 0
    buffer_load_dwordx4 v50, s[48:51], s68 offen lds
    s_add_u32 m0, m0, 1024
    s_nop 0
    buffer_load_dwordx4 v51, s[48:51], s68 offen lds
    s_add_u32 m0, m0, 1024
    s_nop 0
    buffer_load_dwordx4 v52, s[48:51], s68 offen lds
    s_add_u32 m0, m0, 1024
    s_nop 0
    buffer_load_dwordx4 v53, s[48:51], s68 offen lds
    s_add_u32 m0, m0, 1024
    s_nop 0
    buffer_load_dwordx4 v54, s[48:51], s68 offen lds
    s_lshl_b32 s64, s62, 7
    v_add_u32 v5, s64, v2
    v_lshlrev_b32 v6, 4, v5
    v_add_u32 v7, -8, v6
    v_add_u32 v8, 1016, v6
    buffer_load_dwordx2 v[24:25], v7, s[44:47], 0 offen
    buffer_load_dwordx4 v[26:29], v6, s[44:47], 0 offen
    buffer_load_dwordx2 v[32:33], v8, s[44:47], 0 offen
    buffer_load_dwordx4 v[34:37], v6, s[44:47], 0 offen offset:1024
    s_waitcnt vmcnt(20)
    s_barrier
    s_add_u32 s68, s17, 5
    s_and_b32 s68, s68, 7
    s_mul_i32 s68, s68, 229376
    s_add_u32 s68, s68, s66
    s_add_u32 m0, s67, 88064
    s_nop 0
    buffer_load_dwordx4 v48, s[48:51], s68 offen lds
    s_add_u32 m0, m0, 1024
    s_nop 0
    buffer_load_dwordx4 v49, s[48:51], s68 offen lds
    s_add_u32 m0, m0, 1024
    s_nop 0
    buffer_load_dwordx4 v50, s[48:51], s68 offen lds
    s_add_u32 m0, m0, 1024
    s_nop 0
    buffer_load_dwordx4 v51, s[48:51], s68 offen lds
    s_add_u32 m0, m0, 1024
    s_nop 0
    buffer_load_dwordx4 v52, s[48:51], s68 offen lds
    s_add_u32 m0, m0, 1024
    s_nop 0
    buffer_load_dwordx4 v53, s[48:51], s68 offen lds
    s_add_u32 m0, m0, 1024
    s_nop 0
    buffer_load_dwordx4 v54, s[48:51], s68 offen lds
    s_waitcnt vmcnt(20)
    s_barrier
    s_add_u32 s68, s17, 6
    s_and_b32 s68, s68, 7
    s_mul_i32 s68, s68, 229376
    s_add_u32 s68, s68, s66
    s_add_u32 m0, s67, 118784
    s_nop 0
    buffer_load_dwordx4 v48, s[48:51], s68 offen lds
    s_add_u32 m0, m0, 1024
    s_nop 0
    buffer_load_dwordx4 v49, s[48:51], s68 offen lds
    s_add_u32 m0, m0, 1024
    s_nop 0
    buffer_load_dwordx4 v50, s[48:51], s68 offen lds
    s_add_u32 m0, m0, 1024
    s_nop 0
    buffer_load_dwordx4 v51, s[48:51], s68 offen lds
    s_add_u32 m0, m0, 1024
    s_nop 0
    buffer_load_dwordx4 v52, s[48:51], s68 offen lds
    s_add_u32 m0, m0, 1024
    s_nop 0
    buffer_load_dwordx4 v53, s[48:51], s68 offen lds
    s_add_u32 m0, m0, 1024
    s_nop 0
    buffer_load_dwordx4 v54, s[48:51], s68 offen lds
    s_mov_b32 s56, s20
    s_mov_b32 s57, s21
    s_mov_b32 s58, 1835008
    s_mov_b32 s59, 0x00020000
    v_min_u32 v12, 27, v2
    s_mul_i32 s64, s2, 56
    s_sub_u32 s65, s60, 2
    s_mul_i32 s65, s65, 28
    s_add_u32 s64, s64, s65
    v_add_u32 v12, s64, v12
    v_lshlrev_b32 v12, 7, v12
    buffer_load_dword v177, v12, s[56:59], 0 offen
    s_waitcnt vmcnt(19)
    s_barrier
    s_add_u32 s68, s17, 7
    s_and_b32 s68, s68, 7
    s_mul_i32 s68, s68, 229376
    s_add_u32 s68, s68, s66
    s_add_u32 m0, s67, 149504
    s_nop 0
    buffer_load_dwordx4 v48, s[48:51], s68 offen lds
    s_add_u32 m0, m0, 1024
    s_nop 0
    buffer_load_dwordx4 v49, s[48:51], s68 offen lds
    s_add_u32 m0, m0, 1024
    s_nop 0
    buffer_load_dwordx4 v50, s[48:51], s68 offen lds
    s_add_u32 m0, m0, 1024
    s_nop 0
    buffer_load_dwordx4 v51, s[48:51], s68 offen lds
    s_add_u32 m0, m0, 1024
    s_nop 0
    buffer_load_dwordx4 v52, s[48:51], s68 offen lds
    s_add_u32 m0, m0, 1024
    s_nop 0
    buffer_load_dwordx4 v53, s[48:51], s68 offen lds
    s_add_u32 m0, m0, 1024
    s_nop 0
    buffer_load_dwordx4 v54, s[48:51], s68 offen lds
    s_waitcnt vmcnt(15)
    s_barrier
    s_mov_b32 s48, s20
    s_mov_b32 s49, s21
    s_mov_b32 s50, 1835008
    s_mov_b32 s51, 0x00020000
    v_lshrrev_b32 v58, 3, v2
    v_lshrrev_b32 v59, 1, v58
    v_and_b32 v59, 1, v59
    v_and_b32 v60, 7, v2
    v_or_b32 v61, 0, v59
    v_lshlrev_b32 v61, 1, v61
    v_xor_b32 v61, v61, v60
    v_lshlrev_b32 v61, 4, v61
    v_lshl_add_u32 v56, v58, 10, v61
    v_or_b32 v61, 2, v59
    v_lshlrev_b32 v61, 1, v61
    v_xor_b32 v61, v61, v60
    v_lshlrev_b32 v61, 4, v61
    v_lshl_add_u32 v57, v58, 10, v61
    s_sub_u32 s65, s60, 2
    s_lshl_b32 s66, s65, 15
    s_lshl_b32 s64, s38, 7
    s_add_u32 s66, s66, s64
    s_lshl_b32 s67, s65, 12
    s_add_u32 s67, s67, 49152
    s_mov_b32 s71, s16
    s_lshl_b32 s72, s16, 16
    s_add_u32 s72, s72, s66
    s_add_u32 m0, s67, 0
    s_add_u32 s64, s72, 8192
    buffer_load_dwordx4 v56, s[48:51], s72 offen lds
    s_add_u32 m0, m0, 1024
    s_add_u32 s65, s72, 16384
    buffer_load_dwordx4 v57, s[48:51], s64 offen lds
    s_add_u32 m0, m0, 1024
    s_add_u32 s64, s72, 24576
    buffer_load_dwordx4 v56, s[48:51], s65 offen lds
    s_add_u32 m0, m0, 1024
    s_add_u32 s72, s72, 65536
    buffer_load_dwordx4 v57, s[48:51], s64 offen lds
    s_add_u32 s71, s71, 1
    s_cmp_eq_u32 s71, 28
    s_cselect_b32 s72, s66, s72
    s_cselect_b32 s71, 0, s71
    s_add_u32 m0, s67, 8192
    s_add_u32 s64, s72, 8192
    buffer_load_dwordx4 v56, s[48:51], s72 offen lds
    s_add_u32 m0, m0, 1024
    s_add_u32 s65, s72, 16384
    buffer_load_dwordx4 v57, s[48:51], s64 offen lds
    s_add_u32 m0, m0, 1024
    s_add_u32 s64, s72, 24576
    buffer_load_dwordx4 v56, s[48:51], s65 offen lds
    s_add_u32 m0, m0, 1024
    s_add_u32 s72, s72, 65536
    buffer_load_dwordx4 v57, s[48:51], s64 offen lds
    s_add_u32 s71, s71, 1
    s_cmp_eq_u32 s71, 28
    s_cselect_b32 s72, s66, s72
    s_cselect_b32 s71, 0, s71
    s_waitcnt lgkmcnt(0)
    s_waitcnt vmcnt(16)
    s_barrier
    s_add_u32 m0, s67, 16384
    s_add_u32 s64, s72, 8192
    buffer_load_dwordx4 v56, s[48:51], s72 offen lds
    s_add_u32 m0, m0, 1024
    s_add_u32 s65, s72, 16384
    buffer_load_dwordx4 v57, s[48:51], s64 offen lds
    s_add_u32 m0, m0, 1024
    s_add_u32 s64, s72, 24576
    buffer_load_dwordx4 v56, s[48:51], s65 offen lds
    s_add_u32 m0, m0, 1024
    s_add_u32 s72, s72, 65536
    buffer_load_dwordx4 v57, s[48:51], s64 offen lds
    s_add_u32 s71, s71, 1
    s_cmp_eq_u32 s71, 28
    s_cselect_b32 s72, s66, s72
    s_cselect_b32 s71, 0, s71
    s_add_u32 m0, s67, 24576
    s_add_u32 s64, s72, 8192
    buffer_load_dwordx4 v56, s[48:51], s72 offen lds
    s_add_u32 m0, m0, 1024
    s_add_u32 s65, s72, 16384
    buffer_load_dwordx4 v57, s[48:51], s64 offen lds
    s_add_u32 m0, m0, 1024
    s_add_u32 s64, s72, 24576
    buffer_load_dwordx4 v56, s[48:51], s65 offen lds
    s_add_u32 m0, m0, 1024
    s_add_u32 s72, s72, 65536
    buffer_load_dwordx4 v57, s[48:51], s64 offen lds
    s_add_u32 s71, s71, 1
    s_cmp_eq_u32 s71, 28
    s_cselect_b32 s72, s66, s72
    s_cselect_b32 s71, 0, s71
    s_waitcnt lgkmcnt(0)
    s_waitcnt vmcnt(16)
    s_barrier
    s_add_u32 m0, s67, 32768
    s_add_u32 s64, s72, 8192
    buffer_load_dwordx4 v56, s[48:51], s72 offen lds
    s_add_u32 m0, m0, 1024
    s_add_u32 s65, s72, 16384
    buffer_load_dwordx4 v57, s[48:51], s64 offen lds
    s_add_u32 m0, m0, 1024
    s_add_u32 s64, s72, 24576
    buffer_load_dwordx4 v56, s[48:51], s65 offen lds
    s_add_u32 m0, m0, 1024
    s_add_u32 s72, s72, 65536
    buffer_load_dwordx4 v57, s[48:51], s64 offen lds
    s_add_u32 s71, s71, 1
    s_cmp_eq_u32 s71, 28
    s_cselect_b32 s72, s66, s72
    s_cselect_b32 s71, 0, s71
    s_add_u32 m0, s67, 40960
    s_add_u32 s64, s72, 8192
    buffer_load_dwordx4 v56, s[48:51], s72 offen lds
    s_add_u32 m0, m0, 1024
    s_add_u32 s65, s72, 16384
    buffer_load_dwordx4 v57, s[48:51], s64 offen lds
    s_add_u32 m0, m0, 1024
    s_add_u32 s64, s72, 24576
    buffer_load_dwordx4 v56, s[48:51], s65 offen lds
    s_add_u32 m0, m0, 1024
    s_add_u32 s72, s72, 65536
    buffer_load_dwordx4 v57, s[48:51], s64 offen lds
    s_add_u32 s71, s71, 1
    s_cmp_eq_u32 s71, 28
    s_cselect_b32 s72, s66, s72
    s_cselect_b32 s71, 0, s71
    s_waitcnt lgkmcnt(0)
    s_barrier
    s_barrier
    v_lshrrev_b32 v10, 2, v5
    v_lshlrev_b32 v10, 8, v10
    v_and_b32 v6, 3, v5
    v_lshl_add_u32 v10, v6, 4, v10
    s_lshl_b32 s64, s61, 14
    s_add_u32 s64, s64, 8192
    v_add_u32 v10, s64, v10
    v_alignbit_b32 v64, v26, v25, 16
    v_alignbit_b32 v68, v25, v24, 16
    v_mov_b32 v72, v25
    v_alignbit_b32 v65, v27, v26, 16
    v_alignbit_b32 v69, v26, v25, 16
    v_mov_b32 v73, v26
    v_alignbit_b32 v66, v28, v27, 16
    v_alignbit_b32 v70, v27, v26, 16
    v_mov_b32 v74, v27
    v_alignbit_b32 v67, v29, v28, 16
    v_alignbit_b32 v71, v28, v27, 16
    v_mov_b32 v75, v28
    ds_write_b128 v10, v[26:29] offset:0
    ds_write_b128 v10, v[64:67] offset:64
    ds_write_b128 v10, v[72:75] offset:128
    ds_write_b128 v10, v[68:71] offset:192
    v_alignbit_b32 v76, v34, v33, 16
    v_alignbit_b32 v80, v33, v32, 16
    v_mov_b32 v84, v33
    v_alignbit_b32 v77, v35, v34, 16
    v_alignbit_b32 v81, v34, v33, 16
    v_mov_b32 v85, v34
    v_alignbit_b32 v78, v36, v35, 16
    v_alignbit_b32 v82, v35, v34, 16
    v_mov_b32 v86, v35
    v_alignbit_b32 v79, v37, v36, 16
    v_alignbit_b32 v83, v36, v35, 16
    v_mov_b32 v87, v36
    ds_write_b128 v10, v[34:37] offset:4096
    ds_write_b128 v10, v[76:79] offset:4160
    ds_write_b128 v10, v[84:87] offset:4224
    ds_write_b128 v10, v[80:83] offset:4288
    s_waitcnt lgkmcnt(0)
    s_barrier
    s_and_b32 s64, s37, 3
    s_mul_i32 s64, s64, 320
    s_sub_u32 s65, s60, 2
    s_mul_i32 s65, s65, 160
    s_add_u32 s64, s64, s65
    s_add_u32 s64, s64, 512
    v_add_u32 v13, s64, v2
    s_lshl_b32 s65, s38, 7
    v_lshlrev_b32 v14, 10, v13
    buffer_load_dword v176, v14, s[48:51], s65 offen
    v_add_u32 v13, 64, v13
    v_lshlrev_b32 v14, 10, v13
    buffer_load_dword v177, v14, s[48:51], s65 offen
    v_min_u32 v14, 31, v2
    v_add_u32 v13, s64, v14
    v_add_u32 v13, 128, v13
    v_lshlrev_b32 v14, 10, v13
    buffer_load_dword v178, v14, s[48:51], s65 offen
    s_add_u32 s44, s26, 3145728
    s_addc_u32 s45, s27, 0
    s_mov_b32 s46, 2097152
    s_mov_b32 s47, 0x00020000
    v_lshrrev_b32 v10, 3, v2
    v_lshlrev_b32 v10, 12, v10
    v_and_b32 v11, 7, v2
    v_lshl_add_u32 v10, v11, 4, v10
    v_and_b32 v11, 31, v2
    v_lshlrev_b32 v11, 7, v11
    s_lshl_b32 s64, s38, 12
    s_add_u32 s70, s64, 262144
    s_sub_u32 s65, s60, 2
    s_lshl_b32 s73, s38, 18
    s_lshl_b32 s64, s37, 7
    s_add_u32 s73, s73, s64
    s_lshl_b32 s64, s65, 17
    s_add_u32 s73, s73, s64
    s_lshl_b32 s64, s65, 12
    s_add_u32 s69, s64, 40960
    s_waitcnt vmcnt(19)
    s_barrier
    s_sub_u32 s64, s60, 2
    s_lshl_b32 s65, s64, 13
    v_lshlrev_b32 v15, 4, v2
    v_add_u32 v15, 98304, v15
    v_add_u32 v15, s65, v15
    ds_read_b128 v[64:67], v15 offset:4096
    ds_read_b128 v[68:71], v15 offset:5120
    ds_read_b128 v[72:75], v15
    ds_read_b128 v[76:79], v15 offset:1024
    v_lshlrev_b32 v16, 5, v3
    v_lshl_add_u32 v16, v4, 3, v16
    s_lshl_b32 s65, s2, 1
    s_add_u32 s65, s65, s64
    s_lshl_b32 s65, s65, 12
    s_waitcnt lgkmcnt(0)
    buffer_store_dwordx2 v[64:65], v16, s[44:47], s65 offen offset:0 sc1
    buffer_store_dwordx2 v[66:67], v16, s[44:47], s65 offen offset:512 sc1
    buffer_store_dwordx2 v[68:69], v16, s[44:47], s65 offen offset:1024 sc1
    buffer_store_dwordx2 v[70:71], v16, s[44:47], s65 offen offset:1536 sc1
    buffer_store_dwordx2 v[72:73], v16, s[44:47], s65 offen offset:2048 sc1
    buffer_store_dwordx2 v[74:75], v16, s[44:47], s65 offen offset:2560 sc1
    buffer_store_dwordx2 v[76:77], v16, s[44:47], s65 offen offset:3072 sc1
    buffer_store_dwordx2 v[78:79], v16, s[44:47], s65 offen offset:3584 sc1
    s_waitcnt vmcnt(23)
    s_barrier
    s_add_u32 m0, s67, 49152
    s_add_u32 s64, s72, 8192
    buffer_load_dwordx4 v56, s[48:51], s72 offen lds
    s_add_u32 m0, m0, 1024
    s_add_u32 s65, s72, 16384
    buffer_load_dwordx4 v57, s[48:51], s64 offen lds
    s_add_u32 m0, m0, 1024
    s_add_u32 s64, s72, 24576
    buffer_load_dwordx4 v56, s[48:51], s65 offen lds
    s_add_u32 m0, m0, 1024
    s_add_u32 s72, s72, 65536
    buffer_load_dwordx4 v57, s[48:51], s64 offen lds
    s_add_u32 s71, s71, 1
    s_cmp_eq_u32 s71, 28
    s_cselect_b32 s72, s66, s72
    s_cselect_b32 s71, 0, s71
    s_add_u32 m0, s67, 57344
    s_add_u32 s64, s72, 8192
    buffer_load_dwordx4 v56, s[48:51], s72 offen lds
    s_add_u32 m0, m0, 1024
    s_add_u32 s65, s72, 16384
    buffer_load_dwordx4 v57, s[48:51], s64 offen lds
    s_add_u32 m0, m0, 1024
    s_add_u32 s64, s72, 24576
    buffer_load_dwordx4 v56, s[48:51], s65 offen lds
    s_add_u32 m0, m0, 1024
    s_add_u32 s72, s72, 65536
    buffer_load_dwordx4 v57, s[48:51], s64 offen lds
    s_add_u32 s71, s71, 1
    s_cmp_eq_u32 s71, 28
    s_cselect_b32 s72, s66, s72
    s_cselect_b32 s71, 0, s71
    s_add_u32 m0, s67, 0
    s_add_u32 s64, s72, 8192
    buffer_load_dwordx4 v56, s[48:51], s72 offen lds
    s_add_u32 m0, m0, 1024
    s_add_u32 s65, s72, 16384
    buffer_load_dwordx4 v57, s[48:51], s64 offen lds
    s_add_u32 m0, m0, 1024
    s_add_u32 s64, s72, 24576
    buffer_load_dwordx4 v56, s[48:51], s65 offen lds
    s_add_u32 m0, m0, 1024
    s_add_u32 s72, s72, 65536
    buffer_load_dwordx4 v57, s[48:51], s64 offen lds
    s_add_u32 s71, s71, 1
    s_cmp_eq_u32 s71, 28
    s_cselect_b32 s72, s66, s72
    s_cselect_b32 s71, 0, s71
    s_waitcnt vmcnt(31)
    s_barrier
    s_add_u32 m0, s67, 8192
    s_add_u32 s64, s72, 8192
    buffer_load_dwordx4 v56, s[48:51], s72 offen lds
    s_add_u32 m0, m0, 1024
    s_add_u32 s65, s72, 16384
    buffer_load_dwordx4 v57, s[48:51], s64 offen lds
    s_add_u32 m0, m0, 1024
    s_add_u32 s64, s72, 24576
    buffer_load_dwordx4 v56, s[48:51], s65 offen lds
    s_add_u32 m0, m0, 1024
    s_add_u32 s72, s72, 65536
    buffer_load_dwordx4 v57, s[48:51], s64 offen lds
    s_add_u32 s71, s71, 1
    s_cmp_eq_u32 s71, 28
    s_cselect_b32 s72, s66, s72
    s_cselect_b32 s71, 0, s71
    s_waitcnt vmcnt(31)
    s_barrier
    s_add_u32 m0, s67, 16384
    s_add_u32 s64, s72, 8192
    buffer_load_dwordx4 v56, s[48:51], s72 offen lds
    s_add_u32 m0, m0, 1024
    s_add_u32 s65, s72, 16384
    buffer_load_dwordx4 v57, s[48:51], s64 offen lds
    s_add_u32 m0, m0, 1024
    s_add_u32 s64, s72, 24576
    buffer_load_dwordx4 v56, s[48:51], s65 offen lds
    s_add_u32 m0, m0, 1024
    s_add_u32 s72, s72, 65536
    buffer_load_dwordx4 v57, s[48:51], s64 offen lds
    s_add_u32 s71, s71, 1
    s_cmp_eq_u32 s71, 28
    s_cselect_b32 s72, s66, s72
    s_cselect_b32 s71, 0, s71
    s_waitcnt vmcnt(31)
    s_barrier
    s_add_u32 m0, s67, 24576
    s_add_u32 s64, s72, 8192
    buffer_load_dwordx4 v56, s[48:51], s72 offen lds
    s_add_u32 m0, m0, 1024
    s_add_u32 s65, s72, 16384
    buffer_load_dwordx4 v57, s[48:51], s64 offen lds
    s_add_u32 m0, m0, 1024
    s_add_u32 s64, s72, 24576
    buffer_load_dwordx4 v56, s[48:51], s65 offen lds
    s_add_u32 m0, m0, 1024
    s_add_u32 s72, s72, 65536
    buffer_load_dwordx4 v57, s[48:51], s64 offen lds
    s_add_u32 s71, s71, 1
    s_cmp_eq_u32 s71, 28
    s_cselect_b32 s72, s66, s72
    s_cselect_b32 s71, 0, s71
    s_waitcnt vmcnt(20)
    s_barrier
    s_add_u32 m0, s67, 32768
    s_add_u32 s64, s72, 8192
    buffer_load_dwordx4 v56, s[48:51], s72 offen lds
    s_add_u32 m0, m0, 1024
    s_add_u32 s65, s72, 16384
    buffer_load_dwordx4 v57, s[48:51], s64 offen lds
    s_add_u32 m0, m0, 1024
    s_add_u32 s64, s72, 24576
    buffer_load_dwordx4 v56, s[48:51], s65 offen lds
    s_add_u32 m0, m0, 1024
    s_add_u32 s72, s72, 65536
    buffer_load_dwordx4 v57, s[48:51], s64 offen lds
    s_add_u32 s71, s71, 1
    s_cmp_eq_u32 s71, 28
    s_cselect_b32 s72, s66, s72
    s_cselect_b32 s71, 0, s71
    s_waitcnt vmcnt(20)
    s_barrier
    s_add_u32 m0, s67, 40960
    s_add_u32 s64, s72, 8192
    buffer_load_dwordx4 v56, s[48:51], s72 offen lds
    s_add_u32 m0, m0, 1024
    s_add_u32 s65, s72, 16384
    buffer_load_dwordx4 v57, s[48:51], s64 offen lds
    s_add_u32 m0, m0, 1024
    s_add_u32 s64, s72, 24576
    buffer_load_dwordx4 v56, s[48:51], s65 offen lds
    s_add_u32 m0, m0, 1024
    s_add_u32 s72, s72, 65536
    buffer_load_dwordx4 v57, s[48:51], s64 offen lds
    s_add_u32 s71, s71, 1
    s_cmp_eq_u32 s71, 28
    s_cselect_b32 s72, s66, s72
    s_cselect_b32 s71, 0, s71
    s_waitcnt vmcnt(20)
    s_barrier
    s_add_u32 m0, s67, 49152
    s_add_u32 s64, s72, 8192
    buffer_load_dwordx4 v56, s[48:51], s72 offen lds
    s_add_u32 m0, m0, 1024
    s_add_u32 s65, s72, 16384
    buffer_load_dwordx4 v57, s[48:51], s64 offen lds
    s_add_u32 m0, m0, 1024
    s_add_u32 s64, s72, 24576
    buffer_load_dwordx4 v56, s[48:51], s65 offen lds
    s_add_u32 m0, m0, 1024
    s_add_u32 s72, s72, 65536
    buffer_load_dwordx4 v57, s[48:51], s64 offen lds
    s_add_u32 s71, s71, 1
    s_cmp_eq_u32 s71, 28
    s_cselect_b32 s72, s66, s72
    s_cselect_b32 s71, 0, s71
    s_waitcnt vmcnt(20)
    s_barrier
    s_add_u32 m0, s67, 57344
    s_add_u32 s64, s72, 8192
    buffer_load_dwordx4 v56, s[48:51], s72 offen lds
    s_add_u32 m0, m0, 1024
    s_add_u32 s65, s72, 16384
    buffer_load_dwordx4 v57, s[48:51], s64 offen lds
    s_add_u32 m0, m0, 1024
    s_add_u32 s64, s72, 24576
    buffer_load_dwordx4 v56, s[48:51], s65 offen lds
    s_add_u32 m0, m0, 1024
    s_add_u32 s72, s72, 65536
    buffer_load_dwordx4 v57, s[48:51], s64 offen lds
    s_add_u32 s71, s71, 1
    s_cmp_eq_u32 s71, 28
    s_cselect_b32 s72, s66, s72
    s_cselect_b32 s71, 0, s71
    s_waitcnt vmcnt(20)
    s_barrier
    s_add_u32 m0, s67, 0
    s_add_u32 s64, s72, 8192
    buffer_load_dwordx4 v56, s[48:51], s72 offen lds
    s_add_u32 m0, m0, 1024
    s_add_u32 s65, s72, 16384
    buffer_load_dwordx4 v57, s[48:51], s64 offen lds
    s_add_u32 m0, m0, 1024
    s_add_u32 s64, s72, 24576
    buffer_load_dwordx4 v56, s[48:51], s65 offen lds
    s_add_u32 m0, m0, 1024
    s_add_u32 s72, s72, 65536
    buffer_load_dwordx4 v57, s[48:51], s64 offen lds
    s_add_u32 s71, s71, 1
    s_cmp_eq_u32 s71, 28
    s_cselect_b32 s72, s66, s72
    s_cselect_b32 s71, 0, s71
    s_waitcnt vmcnt(20)
    s_barrier
    s_add_u32 m0, s67, 8192
    s_add_u32 s64, s72, 8192
    buffer_load_dwordx4 v56, s[48:51], s72 offen lds
    s_add_u32 m0, m0, 1024
    s_add_u32 s65, s72, 16384
    buffer_load_dwordx4 v57, s[48:51], s64 offen lds
    s_add_u32 m0, m0, 1024
    s_add_u32 s64, s72, 24576
    buffer_load_dwordx4 v56, s[48:51], s65 offen lds
    s_add_u32 m0, m0, 1024
    s_add_u32 s72, s72, 65536
    buffer_load_dwordx4 v57, s[48:51], s64 offen lds
    s_add_u32 s71, s71, 1
    s_cmp_eq_u32 s71, 28
    s_cselect_b32 s72, s66, s72
    s_cselect_b32 s71, 0, s71
    s_waitcnt vmcnt(20)
    s_barrier
    s_add_u32 m0, s67, 16384
    s_add_u32 s64, s72, 8192
    buffer_load_dwordx4 v56, s[48:51], s72 offen lds
    s_add_u32 m0, m0, 1024
    s_add_u32 s65, s72, 16384
    buffer_load_dwordx4 v57, s[48:51], s64 offen lds
    s_add_u32 m0, m0, 1024
    s_add_u32 s64, s72, 24576
    buffer_load_dwordx4 v56, s[48:51], s65 offen lds
    s_add_u32 m0, m0, 1024
    s_add_u32 s72, s72, 65536
    buffer_load_dwordx4 v57, s[48:51], s64 offen lds
    s_add_u32 s71, s71, 1
    s_cmp_eq_u32 s71, 28
    s_cselect_b32 s72, s66, s72
    s_cselect_b32 s71, 0, s71
    s_waitcnt vmcnt(20)
    s_barrier
    s_add_u32 m0, s67, 24576
    s_add_u32 s64, s72, 8192
    buffer_load_dwordx4 v56, s[48:51], s72 offen lds
    s_add_u32 m0, m0, 1024
    s_add_u32 s65, s72, 16384
    buffer_load_dwordx4 v57, s[48:51], s64 offen lds
    s_add_u32 m0, m0, 1024
    s_add_u32 s64, s72, 24576
    buffer_load_dwordx4 v56, s[48:51], s65 offen lds
    s_add_u32 m0, m0, 1024
    s_add_u32 s72, s72, 65536
    buffer_load_dwordx4 v57, s[48:51], s64 offen lds
    s_add_u32 s71, s71, 1
    s_cmp_eq_u32 s71, 28
    s_cselect_b32 s72, s66, s72
    s_cselect_b32 s71, 0, s71
    s_waitcnt vmcnt(20)
    s_barrier
    s_add_u32 m0, s67, 32768
    s_add_u32 s64, s72, 8192
    buffer_load_dwordx4 v56, s[48:51], s72 offen lds
    s_add_u32 m0, m0, 1024
    s_add_u32 s65, s72, 16384
    buffer_load_dwordx4 v57, s[48:51], s64 offen lds
    s_add_u32 m0, m0, 1024
    s_add_u32 s64, s72, 24576
    buffer_load_dwordx4 v56, s[48:51], s65 offen lds
    s_add_u32 m0, m0, 1024
    s_add_u32 s72, s72, 65536
    buffer_load_dwordx4 v57, s[48:51], s64 offen lds
    s_add_u32 s71, s71, 1
    s_cmp_eq_u32 s71, 28
    s_cselect_b32 s72, s66, s72
    s_cselect_b32 s71, 0, s71
    s_waitcnt vmcnt(20)
    s_barrier
    s_add_u32 m0, s67, 40960
    s_add_u32 s64, s72, 8192
    buffer_load_dwordx4 v56, s[48:51], s72 offen lds
    s_add_u32 m0, m0, 1024
    s_add_u32 s65, s72, 16384
    buffer_load_dwordx4 v57, s[48:51], s64 offen lds
    s_add_u32 m0, m0, 1024
    s_add_u32 s64, s72, 24576
    buffer_load_dwordx4 v56, s[48:51], s65 offen lds
    s_add_u32 m0, m0, 1024
    s_add_u32 s72, s72, 65536
    buffer_load_dwordx4 v57, s[48:51], s64 offen lds
    s_add_u32 s71, s71, 1
    s_cmp_eq_u32 s71, 28
    s_cselect_b32 s72, s66, s72
    s_cselect_b32 s71, 0, s71
    s_waitcnt vmcnt(20)
    s_barrier
    s_add_u32 m0, s67, 49152
    s_add_u32 s64, s72, 8192
    buffer_load_dwordx4 v56, s[48:51], s72 offen lds
    s_add_u32 m0, m0, 1024
    s_add_u32 s65, s72, 16384
    buffer_load_dwordx4 v57, s[48:51], s64 offen lds
    s_add_u32 m0, m0, 1024
    s_add_u32 s64, s72, 24576
    buffer_load_dwordx4 v56, s[48:51], s65 offen lds
    s_add_u32 m0, m0, 1024
    s_add_u32 s72, s72, 65536
    buffer_load_dwordx4 v57, s[48:51], s64 offen lds
    s_add_u32 s71, s71, 1
    s_cmp_eq_u32 s71, 28
    s_cselect_b32 s72, s66, s72
    s_cselect_b32 s71, 0, s71
    s_waitcnt vmcnt(20)
    s_barrier
    s_add_u32 m0, s67, 57344
    s_add_u32 s64, s72, 8192
    buffer_load_dwordx4 v56, s[48:51], s72 offen lds
    s_add_u32 m0, m0, 1024
    s_add_u32 s65, s72, 16384
    buffer_load_dwordx4 v57, s[48:51], s64 offen lds
    s_add_u32 m0, m0, 1024
    s_add_u32 s64, s72, 24576
    buffer_load_dwordx4 v56, s[48:51], s65 offen lds
    s_add_u32 m0, m0, 1024
    s_add_u32 s72, s72, 65536
    buffer_load_dwordx4 v57, s[48:51], s64 offen lds
    s_add_u32 s71, s71, 1
    s_cmp_eq_u32 s71, 28
    s_cselect_b32 s72, s66, s72
    s_cselect_b32 s71, 0, s71
    s_waitcnt vmcnt(20)
    s_barrier
    s_add_u32 m0, s67, 0
    s_add_u32 s64, s72, 8192
    buffer_load_dwordx4 v56, s[48:51], s72 offen lds
    s_add_u32 m0, m0, 1024
    s_add_u32 s65, s72, 16384
    buffer_load_dwordx4 v57, s[48:51], s64 offen lds
    s_add_u32 m0, m0, 1024
    s_add_u32 s64, s72, 24576
    buffer_load_dwordx4 v56, s[48:51], s65 offen lds
    s_add_u32 m0, m0, 1024
    s_add_u32 s72, s72, 65536
    buffer_load_dwordx4 v57, s[48:51], s64 offen lds
    s_add_u32 s71, s71, 1
    s_cmp_eq_u32 s71, 28
    s_cselect_b32 s72, s66, s72
    s_cselect_b32 s71, 0, s71
    s_waitcnt vmcnt(20)
    s_barrier
    s_add_u32 m0, s67, 8192
    s_add_u32 s64, s72, 8192
    buffer_load_dwordx4 v56, s[48:51], s72 offen lds
    s_add_u32 m0, m0, 1024
    s_add_u32 s65, s72, 16384
    buffer_load_dwordx4 v57, s[48:51], s64 offen lds
    s_add_u32 m0, m0, 1024
    s_add_u32 s64, s72, 24576
    buffer_load_dwordx4 v56, s[48:51], s65 offen lds
    s_add_u32 m0, m0, 1024
    s_add_u32 s72, s72, 65536
    buffer_load_dwordx4 v57, s[48:51], s64 offen lds
    s_add_u32 s71, s71, 1
    s_cmp_eq_u32 s71, 28
    s_cselect_b32 s72, s66, s72
    s_cselect_b32 s71, 0, s71
    s_waitcnt vmcnt(20)
    s_barrier
    s_add_u32 m0, s67, 16384
    s_add_u32 s64, s72, 8192
    buffer_load_dwordx4 v56, s[48:51], s72 offen lds
    s_add_u32 m0, m0, 1024
    s_add_u32 s65, s72, 16384
    buffer_load_dwordx4 v57, s[48:51], s64 offen lds
    s_add_u32 m0, m0, 1024
    s_add_u32 s64, s72, 24576
    buffer_load_dwordx4 v56, s[48:51], s65 offen lds
    s_add_u32 m0, m0, 1024
    s_add_u32 s72, s72, 65536
    buffer_load_dwordx4 v57, s[48:51], s64 offen lds
    s_add_u32 s71, s71, 1
    s_cmp_eq_u32 s71, 28
    s_cselect_b32 s72, s66, s72
    s_cselect_b32 s71, 0, s71
    s_waitcnt vmcnt(20)
    s_barrier
    s_add_u32 m0, s67, 24576
    s_add_u32 s64, s72, 8192
    buffer_load_dwordx4 v56, s[48:51], s72 offen lds
    s_add_u32 m0, m0, 1024
    s_add_u32 s65, s72, 16384
    buffer_load_dwordx4 v57, s[48:51], s64 offen lds
    s_add_u32 m0, m0, 1024
    s_add_u32 s64, s72, 24576
    buffer_load_dwordx4 v56, s[48:51], s65 offen lds
    s_add_u32 m0, m0, 1024
    s_add_u32 s72, s72, 65536
    buffer_load_dwordx4 v57, s[48:51], s64 offen lds
    s_add_u32 s71, s71, 1
    s_cmp_eq_u32 s71, 28
    s_cselect_b32 s72, s66, s72
    s_cselect_b32 s71, 0, s71
    s_waitcnt vmcnt(20)
    s_barrier
    buffer_load_dword v14, v11, s[28:31], s70 offen sc1
    s_waitcnt vmcnt(16)
    s_barrier
    s_waitcnt vmcnt(0)
    v_cmp_ne_u32 vcc, s32, v14
    s_nop 1
    s_cbranch_vccz L_yok_26
    s_mov_b32 s39, 200000
L_poll_27:
    buffer_load_dword v14, v11, s[28:31], s70 offen sc1
    s_waitcnt vmcnt(0)
    v_cmp_ne_u32 vcc, s32, v14
    s_nop 1
    s_mov_b64 s[74:75], vcc
    s_cmp_eq_u64 s[74:75], 0
    s_cbranch_scc1 L_pdone_28
    s_sub_u32 s39, s39, 1
    s_cbranch_scc1 L_pdone_28
    s_sleep 1
    s_branch L_poll_27
L_pdone_28:
L_yok_26:
    s_mov_b32 m0, s69
    s_nop 0
    buffer_load_dwordx4 v10, s[44:47], s73 offen sc1 lds
    s_add_u32 m0, m0, 1024
    s_add_u32 s73, s73, 32768
    buffer_load_dwordx4 v10, s[44:47], s73 offen sc1 lds
    s_add_u32 m0, m0, 1024
    s_add_u32 s73, s73, 32768
    buffer_load_dwordx4 v10, s[44:47], s73 offen sc1 lds
    s_add_u32 m0, m0, 1024
    s_add_u32 s73, s73, 32768
    buffer_load_dwordx4 v10, s[44:47], s73 offen sc1 lds
    s_barrier
    s_barrier
    s_barrier
    s_barrier
    s_barrier
    s_waitcnt vmcnt(0)
    s_barrier
L_end:
    s_endpgm
L_code_end:
.section .rodata,"a"
.p2align 6
.amdhsa_kernel parallel_sum__ssm_conv_h3__dense_activation_silu__prompt_kernel
  .amdhsa_next_free_vgpr 216
  .amdhsa_next_free_sgpr 96
  .amdhsa_accum_offset 216
  .amdhsa_group_segment_fixed_size 0
  .amdhsa_kernarg_size 96
  .amdhsa_user_sgpr_count 2
  .amdhsa_user_sgpr_kernarg_segment_ptr 1
  .amdhsa_system_sgpr_workgroup_id_x 1
  .amdhsa_float_denorm_mode_32 3
.end_amdhsa_kernel
```
